```python
import torch

def _softmax(x, axis=-1):
    return torch.softmax(x, dim=axis)
def _gelu(x):
    return torch.nn.functional.gelu(x, approximate="tanh")
def _silu(x):
    return torch.nn.functional.silu(x)
def _sigmoid(x):
    return torch.sigmoid(x)
def _layernorm(x, axis=-1, eps=1e-5):
    m = x.mean(dim=axis, keepdim=True)
    v = x.var(dim=axis, keepdim=True, unbiased=False)
    return (x - m) / torch.sqrt(v + eps)
def _scatter_add(tgt, idx, src, axis=0):
    return tgt.clone().index_add_(axis, idx, src)
def _segment_sum(src, seg, n):
    out = torch.zeros((n,) + src.shape[1:], dtype=src.dtype)
    return out.index_add_(0, seg, src)
def _pad(x, pw):
    flat = tuple(v for pair in reversed(pw) for v in pair)
    return torch.nn.functional.pad(x, flat)

kernel_name = 'sequential_preLN__softmax_full_mha__swiglu_ffn__prompt'

def setup_inputs():

    _w = (lambda a: (lambda t: t.to(torch.bfloat16) if t.is_floating_point() else t)(torch.as_tensor(a)))
    def _A_setup():
        B, S, D = 1, 2048, 512
        return {
            "x": _w((lambda *s: torch.randn(*s, dtype=torch.bfloat16) * 0.05)(B, S, D)),
            "wqkv": _w((lambda *s: torch.randn(*s, dtype=torch.bfloat16) * 0.05)(D, 3 * D)),
            "wo": _w((lambda *s: torch.randn(*s, dtype=torch.bfloat16) * 0.05)(D, D)),
        }
    _A_in = _A_setup()

    def _B_setup():
        B, S, D, F = 1, 2048, 512, 1376
        return {
            "x": _w((lambda *s: torch.randn(*s, dtype=torch.bfloat16) * 0.05)(B, S, D)),
            "w_gate": _w((lambda *s: torch.randn(*s, dtype=torch.bfloat16) * 0.05)(D, F)),
            "w_up": _w((lambda *s: torch.randn(*s, dtype=torch.bfloat16) * 0.05)(D, F)),
            "w_down": _w((lambda *s: torch.randn(*s, dtype=torch.bfloat16) * 0.05)(F, D)),
        }
    _B_in = _B_setup()

    return {
        "A_x": _A_in["x"],
        "A_wqkv": _A_in["wqkv"],
        "A_wo": _A_in["wo"],
        "B_x": _B_in["x"],
        "B_w_gate": _B_in["w_gate"],
        "B_w_up": _B_in["w_up"],
        "B_w_down": _B_in["w_down"],
    }

def reference(A_x, A_wqkv, A_wo, B_x, B_w_gate, B_w_up, B_w_down):
    def _A_ref(x, wqkv, wo):
        B, S, D = x.shape
        H = 32; Dh = D // H
        qkv = (lambda x, *d: x.permute(*d))((x @ wqkv).reshape(B, S, 3, H, Dh), 2, 0, 3, 1, 4)
        q, k, v = qkv[0], qkv[1], qkv[2]
        scale = Dh ** -0.5
        scores = torch.einsum("bhqd,bhkd->bhqk", q, k) * scale
        p = _softmax(scores, axis=-1)
        o = torch.einsum("bhqk,bhkd->bhqd", p, v)
        return (lambda x, *d: x.permute(*d))(o, 0, 2, 1, 3).reshape(B, S, D) @ wo

    def _B_ref(x, w_gate, w_up, w_down):
        g = _silu(x @ w_gate)
        u = x @ w_up
        return (g * u) @ w_down

    x = A_x
    h = x + _A_ref(_layernorm(x, axis=-1), A_wqkv, A_wo)
    h2 = h + _B_ref(_layernorm(h, axis=-1), B_w_gate, B_w_up, B_w_down)
    return h2
```

```asm
; @launch grid=(256,1,1) block=(512,1,1) lds=163840
.amdgcn_target "amdgcn-amd-amdhsa--gfx950"
.text
.globl sequential_preLN__softmax_full_mha__swiglu_ffn__prompt_kernel
.p2align 8
.type sequential_preLN__softmax_full_mha__swiglu_ffn__prompt_kernel,@function
sequential_preLN__softmax_full_mha__swiglu_ffn__prompt_kernel:
    s_getpc_b64 s[4:5]
    s_cmp_ge_u32 s2, 256
    s_cbranch_scc1 L_sequential_preLN__softmax_full_mha__swiglu_ffn__prompt_end_1
    s_load_dwordx2 s[8:9], s[0:1], 72
    s_load_dwordx2 s[12:13], s[0:1], 0
    s_load_dwordx2 s[16:17], s[0:1], 8
    s_load_dwordx2 s[20:21], s[0:1], 16
    s_load_dwordx2 s[24:25], s[0:1], 32
    s_load_dwordx2 s[28:29], s[0:1], 40
    s_load_dwordx2 s[32:33], s[0:1], 48
    s_load_dwordx2 s[36:37], s[0:1], 56
    s_load_dwordx2 s[40:41], s[0:1], 64
    v_lshrrev_b32 v3, 6, v0
    v_and_b32 v1, 63, v0
    v_readfirstlane_b32 s3, v3
    v_lshlrev_b32 v2, 4, v1
    s_mov_b32 s10, 26214400
    s_mov_b32 s11, 0x00020000
    s_mov_b32 s14, 2097152
    s_mov_b32 s15, 0x00020000
    s_mov_b32 s18, 1572864
    s_mov_b32 s19, 0x00020000
    s_mov_b32 s22, 524288
    s_mov_b32 s23, 0x00020000
    s_mov_b32 s26, 1409024
    s_mov_b32 s27, 0x00020000
    s_mov_b32 s30, 1409024
    s_mov_b32 s31, 0x00020000
    s_mov_b32 s34, 1409024
    s_mov_b32 s35, 0x00020000
    s_mov_b32 s38, 2097152
    s_mov_b32 s39, 0x00020000
    s_mov_b32 s42, 256
    s_mov_b32 s43, 0x00020000
    s_cmp_lg_u32 s3, 7
    s_cbranch_scc1 L_sequential_preLN__softmax_full_mha__swiglu_ffn__prompt_nocodepf_2
    s_lshr_b32 s6, s2, 3
    s_mul_i32 s6, s6, 43
    s_lshr_b32 s6, s6, 8
    s_lshl_b32 s6, s6, 13
    v_lshlrev_b32 v4, 7, v1
    v_add_u32 v4, s6, v4
    s_mov_b32 s6, L_sequential_preLN__softmax_full_mha__swiglu_ffn__prompt_end_1-sequential_preLN__softmax_full_mha__swiglu_ffn__prompt_kernel-8
    v_min_u32 v4, s6, v4
    v_and_b32 v4, 0xfffffffc, v4
    global_load_dword v5, v4, s[4:5]
L_sequential_preLN__softmax_full_mha__swiglu_ffn__prompt_nocodepf_2:
    s_and_b32 s6, s2, 7
    s_lshl_b32 s6, s6, 7
    s_mov_b32 s46, 0
    s_getreg_b32 s47, hwreg(HW_REG_XCC_ID, 0, 4)
    s_add_u32 s47, s47, 1
    s_bfe_u32 s48, s2, 0x20001
    s_lshl_b32 s48, s48, 3
    s_bfe_u32 s52, s2, 0x30003
    s_add_u32 s48, s48, s52
    s_and_b32 s49, s2, 1
    s_lshl_b32 s49, s49, 2
    s_lshr_b32 s50, s2, 6
    s_add_u32 s49, s49, s50
    v_lshrrev_b32 v52, 3, v1
    v_and_b32 v53, 7, v1
    v_lshlrev_b32 v3, 10, v52
    v_lshl_add_u32 v3, v53, 4, v3
    s_lshl_b32 s51, s48, 16
    s_lshl_b32 s50, s3, 13
    s_add_u32 s51, s51, s50
    s_waitcnt lgkmcnt(0)
    buffer_load_dwordx4 v[20:23], v3, s[12:15], s51 offen offset:0
    buffer_load_dwordx4 v[24:27], v3, s[12:15], s51 offen offset:128
    buffer_load_dwordx4 v[28:31], v3, s[12:15], s51 offen offset:256
    buffer_load_dwordx4 v[32:35], v3, s[12:15], s51 offen offset:384
    buffer_load_dwordx4 v[36:39], v3, s[12:15], s51 offen offset:512
    buffer_load_dwordx4 v[40:43], v3, s[12:15], s51 offen offset:640
    buffer_load_dwordx4 v[44:47], v3, s[12:15], s51 offen offset:768
    buffer_load_dwordx4 v[48:51], v3, s[12:15], s51 offen offset:896
    v_bfe_u32 v54, v1, 4, 1
    v_lshlrev_b32 v54, 2, v54
    v_xor_b32 v54, v54, v53
    v_mul_u32_u24 v7, 3072, v52
    v_lshl_add_u32 v7, v54, 4, v7
    s_cmp_lg_u32 s3, 3
    s_cbranch_scc1 L_sequential_preLN__softmax_full_mha__swiglu_ffn__prompt_noclr_3
    v_mov_b32 v16, 0
    v_mov_b32 v17, 0
    s_and_b32 s7, s2, 1
    s_lshl_b32 s7, s7, 2
    s_lshr_b32 s45, s2, 6
    s_add_u32 s7, s7, s45
    s_lshl_b32 s7, s7, 5
    s_bfe_u32 s45, s2, 0x20001
    s_lshl_b32 s45, s45, 3
    s_add_u32 s7, s7, s45
    s_bfe_u32 s45, s2, 0x30003
    s_add_u32 s7, s7, s45
    s_lshl_b32 s7, s7, 2
    s_add_u32 s7, s7, 22937600
    v_writelane_b32 v17, s7, 0
    s_lshr_b32 s7, s2, 5
    s_lshl_b32 s7, s7, 5
    s_and_b32 s45, s2, 7
    s_lshl_b32 s45, s45, 2
    s_add_u32 s7, s7, s45
    s_bfe_u32 s45, s2, 0x20003
    s_add_u32 s7, s7, s45
    s_lshl_b32 s7, s7, 2
    s_add_u32 s7, s7, 22938624
    v_writelane_b32 v17, s7, 1
    s_lshr_b32 s7, s2, 3
    s_lshl_b32 s7, s7, 2
    s_add_u32 s7, s7, s6
    s_add_u32 s7, s7, 22939648
    v_writelane_b32 v17, s7, 2
    s_lshr_b32 s7, s2, 3
    s_lshl_b32 s7, s7, 2
    s_add_u32 s7, s7, s6
    s_add_u32 s7, s7, 22940672
    v_writelane_b32 v17, s7, 3
    s_lshl_b32 s7, s2, 2
    s_add_u32 s7, s7, 22941696
    v_writelane_b32 v17, s7, 4
    s_lshl_b32 s7, s2, 2
    s_add_u32 s7, s7, 22942720
    v_writelane_b32 v17, s7, 5
    s_lshl_b32 s7, s2, 2
    s_add_u32 s7, s7, 22943744
    v_writelane_b32 v17, s7, 6
    s_lshr_b32 s7, s2, 3
    s_lshl_b32 s7, s7, 2
    s_add_u32 s7, s7, s6
    s_add_u32 s7, s7, 22945792
    v_writelane_b32 v17, s7, 7
    v_writelane_b32 v16, s47, 7
    s_mov_b64 exec, 0xff
    buffer_store_dword v16, v17, s[8:11], 0 offen sc1
    s_mov_b64 exec, -1
L_sequential_preLN__softmax_full_mha__swiglu_ffn__prompt_noclr_3:
    s_lshr_b32 s50, s3, 2
    s_lshl_b32 s50, s50, 15
    s_and_b32 s51, s3, 3
    s_lshl_b32 s51, s51, 3
    v_add_u32 v55, s51, v52
    v_xor_b32 v55, v55, v53
    v_lshlrev_b32 v6, 4, v55
    v_lshrrev_b32 v55, 1, v53
    v_lshl_add_u32 v6, v55, 10, v6
    v_and_b32 v55, 1, v53
    v_lshl_add_u32 v6, v55, 9, v6
    v_add_u32 v6, s50, v6
    s_cmp_ge_u32 s3, 4
    s_cbranch_scc1 L_sequential_preLN__softmax_full_mha__swiglu_ffn__prompt_p1_loader_4
    s_sub_u32 s54, s3, 0
    s_mul_i32 s54, s54, 6
    s_lshl_b32 s53, s54, 10
    s_add_u32 s53, s53, 65536
    s_add_u32 s50, s54, 0
    s_lshr_b32 s51, s50, 3
    s_and_b32 s50, s50, 7
    s_mul_i32 s56, s50, 24576
    s_lshl_b32 s51, s51, 10
    s_add_u32 s56, s56, s51
    s_lshl_b32 s51, s49, 7
    s_add_u32 s56, s56, s51
    s_add_u32 s50, s54, 1
    s_lshr_b32 s51, s50, 3
    s_and_b32 s50, s50, 7
    s_mul_i32 s57, s50, 24576
    s_lshl_b32 s51, s51, 10
    s_add_u32 s57, s57, s51
    s_lshl_b32 s51, s49, 7
    s_add_u32 s57, s57, s51
    s_add_u32 s50, s54, 2
    s_lshr_b32 s51, s50, 3
    s_and_b32 s50, s50, 7
    s_mul_i32 s58, s50, 24576
    s_lshl_b32 s51, s51, 10
    s_add_u32 s58, s58, s51
    s_lshl_b32 s51, s49, 7
    s_add_u32 s58, s58, s51
    s_add_u32 s50, s54, 3
    s_lshr_b32 s51, s50, 3
    s_and_b32 s50, s50, 7
    s_mul_i32 s59, s50, 24576
    s_lshl_b32 s51, s51, 10
    s_add_u32 s59, s59, s51
    s_lshl_b32 s51, s49, 7
    s_add_u32 s59, s59, s51
    s_add_u32 s50, s54, 4
    s_lshr_b32 s51, s50, 3
    s_and_b32 s50, s50, 7
    s_mul_i32 s60, s50, 24576
    s_lshl_b32 s51, s51, 10
    s_add_u32 s60, s60, s51
    s_lshl_b32 s51, s49, 7
    s_add_u32 s60, s60, s51
    s_add_u32 s50, s54, 5
    s_lshr_b32 s51, s50, 3
    s_and_b32 s50, s50, 7
    s_mul_i32 s61, s50, 24576
    s_lshl_b32 s51, s51, 10
    s_add_u32 s61, s61, s51
    s_lshl_b32 s51, s49, 7
    s_add_u32 s61, s61, s51
    v_mov_b32 v54, 0x3f803f80
    s_cmp_eq_u32 s3, 3
    s_cbranch_scc1 L_sequential_preLN__softmax_full_mha__swiglu_ffn__prompt_xw3_6
    s_waitcnt vmcnt(0)
    s_branch L_sequential_preLN__softmax_full_mha__swiglu_ffn__prompt_xwj_7
L_sequential_preLN__softmax_full_mha__swiglu_ffn__prompt_xw3_6:
    s_waitcnt vmcnt(1)
L_sequential_preLN__softmax_full_mha__swiglu_ffn__prompt_xwj_7:
    v_dot2_f32_bf16 v56, v20, v54, 0
    v_dot2_f32_bf16 v60, v20, v20, 0
    v_dot2_f32_bf16 v57, v21, v54, 0
    v_dot2_f32_bf16 v61, v21, v21, 0
    v_dot2_f32_bf16 v58, v22, v54, 0
    v_dot2_f32_bf16 v62, v22, v22, 0
    v_dot2_f32_bf16 v59, v23, v54, 0
    v_dot2_f32_bf16 v63, v23, v23, 0
    v_dot2_f32_bf16 v56, v24, v54, v56
    v_dot2_f32_bf16 v60, v24, v24, v60
    v_dot2_f32_bf16 v57, v25, v54, v57
    v_dot2_f32_bf16 v61, v25, v25, v61
    v_dot2_f32_bf16 v58, v26, v54, v58
    v_dot2_f32_bf16 v62, v26, v26, v62
    v_dot2_f32_bf16 v59, v27, v54, v59
    v_dot2_f32_bf16 v63, v27, v27, v63
    v_dot2_f32_bf16 v56, v28, v54, v56
    v_dot2_f32_bf16 v60, v28, v28, v60
    v_dot2_f32_bf16 v57, v29, v54, v57
    v_dot2_f32_bf16 v61, v29, v29, v61
    v_dot2_f32_bf16 v58, v30, v54, v58
    v_dot2_f32_bf16 v62, v30, v30, v62
    v_dot2_f32_bf16 v59, v31, v54, v59
    v_dot2_f32_bf16 v63, v31, v31, v63
    v_dot2_f32_bf16 v56, v32, v54, v56
    v_dot2_f32_bf16 v60, v32, v32, v60
    v_dot2_f32_bf16 v57, v33, v54, v57
    v_dot2_f32_bf16 v61, v33, v33, v61
    v_dot2_f32_bf16 v58, v34, v54, v58
    v_dot2_f32_bf16 v62, v34, v34, v62
    v_dot2_f32_bf16 v59, v35, v54, v59
    v_dot2_f32_bf16 v63, v35, v35, v63
    v_dot2_f32_bf16 v56, v36, v54, v56
    v_dot2_f32_bf16 v60, v36, v36, v60
    v_dot2_f32_bf16 v57, v37, v54, v57
    v_dot2_f32_bf16 v61, v37, v37, v61
    v_dot2_f32_bf16 v58, v38, v54, v58
    v_dot2_f32_bf16 v62, v38, v38, v62
    v_dot2_f32_bf16 v59, v39, v54, v59
    v_dot2_f32_bf16 v63, v39, v39, v63
    v_dot2_f32_bf16 v56, v40, v54, v56
    v_dot2_f32_bf16 v60, v40, v40, v60
    v_dot2_f32_bf16 v57, v41, v54, v57
    v_dot2_f32_bf16 v61, v41, v41, v61
    v_dot2_f32_bf16 v58, v42, v54, v58
    v_dot2_f32_bf16 v62, v42, v42, v62
    v_dot2_f32_bf16 v59, v43, v54, v59
    v_dot2_f32_bf16 v63, v43, v43, v63
    v_dot2_f32_bf16 v56, v44, v54, v56
    v_dot2_f32_bf16 v60, v44, v44, v60
    v_dot2_f32_bf16 v57, v45, v54, v57
    v_dot2_f32_bf16 v61, v45, v45, v61
    v_dot2_f32_bf16 v58, v46, v54, v58
    v_dot2_f32_bf16 v62, v46, v46, v62
    v_dot2_f32_bf16 v59, v47, v54, v59
    v_dot2_f32_bf16 v63, v47, v47, v63
    v_dot2_f32_bf16 v56, v48, v54, v56
    v_dot2_f32_bf16 v60, v48, v48, v60
    v_dot2_f32_bf16 v57, v49, v54, v57
    v_dot2_f32_bf16 v61, v49, v49, v61
    v_dot2_f32_bf16 v58, v50, v54, v58
    v_dot2_f32_bf16 v62, v50, v50, v62
    v_dot2_f32_bf16 v59, v51, v54, v59
    v_dot2_f32_bf16 v63, v51, v51, v63
    s_nop 2
    v_add_f32 v56, v56, v57
    v_add_f32 v60, v60, v61
    v_add_f32 v58, v58, v59
    v_add_f32 v62, v62, v63
    v_add_f32 v56, v56, v58
    v_add_f32 v60, v60, v62
    s_nop 1
    v_add_f32_dpp v56, v56, v56 quad_perm:[1,0,3,2] row_mask:0xf bank_mask:0xf
    v_add_f32_dpp v60, v60, v60 quad_perm:[1,0,3,2] row_mask:0xf bank_mask:0xf
    s_nop 1
    v_add_f32_dpp v56, v56, v56 quad_perm:[2,3,0,1] row_mask:0xf bank_mask:0xf
    v_add_f32_dpp v60, v60, v60 quad_perm:[2,3,0,1] row_mask:0xf bank_mask:0xf
    s_nop 1
    v_add_f32_dpp v56, v56, v56 row_half_mirror row_mask:0xf bank_mask:0xf
    v_add_f32_dpp v60, v60, v60 row_half_mirror row_mask:0xf bank_mask:0xf
    v_mul_f32 v56, 0x3b000000, v56
    v_mul_f32 v60, 0x3b000000, v60
    v_fma_f32 v60, -v56, v56, v60
    v_max_f32 v60, 0, v60
    v_add_f32 v60, 0x3727c5ac, v60
    v_rsq_f32 v64, v60
    s_nop 0
    v_mov_b32 v65, v64
    v_mul_f32 v66, -v56, v64
    v_mov_b32 v67, v66
    v_lshlrev_b32 v68, 16, v20
    v_and_b32 v69, 0xffff0000, v20
    v_lshlrev_b32 v70, 16, v21
    v_and_b32 v71, 0xffff0000, v21
    v_lshlrev_b32 v72, 16, v22
    v_and_b32 v73, 0xffff0000, v22
    v_lshlrev_b32 v74, 16, v23
    v_and_b32 v75, 0xffff0000, v23
    v_lshlrev_b32 v76, 16, v24
    v_and_b32 v77, 0xffff0000, v24
    v_lshlrev_b32 v78, 16, v25
    v_and_b32 v79, 0xffff0000, v25
    v_lshlrev_b32 v80, 16, v26
    v_and_b32 v81, 0xffff0000, v26
    v_lshlrev_b32 v82, 16, v27
    v_and_b32 v83, 0xffff0000, v27
    v_pk_fma_f32 v[68:69], v[68:69], v[64:65], v[66:67]
    v_pk_fma_f32 v[70:71], v[70:71], v[64:65], v[66:67]
    v_pk_fma_f32 v[72:73], v[72:73], v[64:65], v[66:67]
    v_pk_fma_f32 v[74:75], v[74:75], v[64:65], v[66:67]
    v_pk_fma_f32 v[76:77], v[76:77], v[64:65], v[66:67]
    v_pk_fma_f32 v[78:79], v[78:79], v[64:65], v[66:67]
    v_pk_fma_f32 v[80:81], v[80:81], v[64:65], v[66:67]
    v_pk_fma_f32 v[82:83], v[82:83], v[64:65], v[66:67]
    v_cvt_pk_bf16_f32 v20, v68, v69
    v_cvt_pk_bf16_f32 v21, v70, v71
    v_cvt_pk_bf16_f32 v22, v72, v73
    v_cvt_pk_bf16_f32 v23, v74, v75
    ds_write_b128 v6, v[20:23] offset:0
    v_cvt_pk_bf16_f32 v24, v76, v77
    v_cvt_pk_bf16_f32 v25, v78, v79
    v_cvt_pk_bf16_f32 v26, v80, v81
    v_cvt_pk_bf16_f32 v27, v82, v83
    ds_write_b128 v6, v[24:27] offset:4096
    v_lshlrev_b32 v68, 16, v28
    v_and_b32 v69, 0xffff0000, v28
    v_lshlrev_b32 v70, 16, v29
    v_and_b32 v71, 0xffff0000, v29
    v_lshlrev_b32 v72, 16, v30
    v_and_b32 v73, 0xffff0000, v30
    v_lshlrev_b32 v74, 16, v31
    v_and_b32 v75, 0xffff0000, v31
    v_lshlrev_b32 v76, 16, v32
    v_and_b32 v77, 0xffff0000, v32
    v_lshlrev_b32 v78, 16, v33
    v_and_b32 v79, 0xffff0000, v33
    v_lshlrev_b32 v80, 16, v34
    v_and_b32 v81, 0xffff0000, v34
    v_lshlrev_b32 v82, 16, v35
    v_and_b32 v83, 0xffff0000, v35
    v_pk_fma_f32 v[68:69], v[68:69], v[64:65], v[66:67]
    v_pk_fma_f32 v[70:71], v[70:71], v[64:65], v[66:67]
    v_pk_fma_f32 v[72:73], v[72:73], v[64:65], v[66:67]
    v_pk_fma_f32 v[74:75], v[74:75], v[64:65], v[66:67]
    v_pk_fma_f32 v[76:77], v[76:77], v[64:65], v[66:67]
    v_pk_fma_f32 v[78:79], v[78:79], v[64:65], v[66:67]
    v_pk_fma_f32 v[80:81], v[80:81], v[64:65], v[66:67]
    v_pk_fma_f32 v[82:83], v[82:83], v[64:65], v[66:67]
    v_cvt_pk_bf16_f32 v28, v68, v69
    v_cvt_pk_bf16_f32 v29, v70, v71
    v_cvt_pk_bf16_f32 v30, v72, v73
    v_cvt_pk_bf16_f32 v31, v74, v75
    ds_write_b128 v6, v[28:31] offset:8192
    v_cvt_pk_bf16_f32 v32, v76, v77
    v_cvt_pk_bf16_f32 v33, v78, v79
    v_cvt_pk_bf16_f32 v34, v80, v81
    v_cvt_pk_bf16_f32 v35, v82, v83
    ds_write_b128 v6, v[32:35] offset:12288
    v_lshlrev_b32 v68, 16, v36
    v_and_b32 v69, 0xffff0000, v36
    v_lshlrev_b32 v70, 16, v37
    v_and_b32 v71, 0xffff0000, v37
    v_lshlrev_b32 v72, 16, v38
    v_and_b32 v73, 0xffff0000, v38
    v_lshlrev_b32 v74, 16, v39
    v_and_b32 v75, 0xffff0000, v39
    v_lshlrev_b32 v76, 16, v40
    v_and_b32 v77, 0xffff0000, v40
    v_lshlrev_b32 v78, 16, v41
    v_and_b32 v79, 0xffff0000, v41
    v_lshlrev_b32 v80, 16, v42
    v_and_b32 v81, 0xffff0000, v42
    v_lshlrev_b32 v82, 16, v43
    v_and_b32 v83, 0xffff0000, v43
    v_pk_fma_f32 v[68:69], v[68:69], v[64:65], v[66:67]
    v_pk_fma_f32 v[70:71], v[70:71], v[64:65], v[66:67]
    v_pk_fma_f32 v[72:73], v[72:73], v[64:65], v[66:67]
    v_pk_fma_f32 v[74:75], v[74:75], v[64:65], v[66:67]
    v_pk_fma_f32 v[76:77], v[76:77], v[64:65], v[66:67]
    v_pk_fma_f32 v[78:79], v[78:79], v[64:65], v[66:67]
    v_pk_fma_f32 v[80:81], v[80:81], v[64:65], v[66:67]
    v_pk_fma_f32 v[82:83], v[82:83], v[64:65], v[66:67]
    v_cvt_pk_bf16_f32 v36, v68, v69
    v_cvt_pk_bf16_f32 v37, v70, v71
    v_cvt_pk_bf16_f32 v38, v72, v73
    v_cvt_pk_bf16_f32 v39, v74, v75
    ds_write_b128 v6, v[36:39] offset:16384
    v_cvt_pk_bf16_f32 v40, v76, v77
    v_cvt_pk_bf16_f32 v41, v78, v79
    v_cvt_pk_bf16_f32 v42, v80, v81
    v_cvt_pk_bf16_f32 v43, v82, v83
    ds_write_b128 v6, v[40:43] offset:20480
    v_lshlrev_b32 v68, 16, v44
    v_and_b32 v69, 0xffff0000, v44
    v_lshlrev_b32 v70, 16, v45
    v_and_b32 v71, 0xffff0000, v45
    v_lshlrev_b32 v72, 16, v46
    v_and_b32 v73, 0xffff0000, v46
    v_lshlrev_b32 v74, 16, v47
    v_and_b32 v75, 0xffff0000, v47
    v_lshlrev_b32 v76, 16, v48
    v_and_b32 v77, 0xffff0000, v48
    v_lshlrev_b32 v78, 16, v49
    v_and_b32 v79, 0xffff0000, v49
    v_lshlrev_b32 v80, 16, v50
    v_and_b32 v81, 0xffff0000, v50
    v_lshlrev_b32 v82, 16, v51
    v_and_b32 v83, 0xffff0000, v51
    v_pk_fma_f32 v[68:69], v[68:69], v[64:65], v[66:67]
    v_pk_fma_f32 v[70:71], v[70:71], v[64:65], v[66:67]
    v_pk_fma_f32 v[72:73], v[72:73], v[64:65], v[66:67]
    v_pk_fma_f32 v[74:75], v[74:75], v[64:65], v[66:67]
    v_pk_fma_f32 v[76:77], v[76:77], v[64:65], v[66:67]
    v_pk_fma_f32 v[78:79], v[78:79], v[64:65], v[66:67]
    v_pk_fma_f32 v[80:81], v[80:81], v[64:65], v[66:67]
    v_pk_fma_f32 v[82:83], v[82:83], v[64:65], v[66:67]
    v_cvt_pk_bf16_f32 v44, v68, v69
    v_cvt_pk_bf16_f32 v45, v70, v71
    v_cvt_pk_bf16_f32 v46, v72, v73
    v_cvt_pk_bf16_f32 v47, v74, v75
    ds_write_b128 v6, v[44:47] offset:24576
    v_cvt_pk_bf16_f32 v48, v76, v77
    v_cvt_pk_bf16_f32 v49, v78, v79
    v_cvt_pk_bf16_f32 v50, v80, v81
    v_cvt_pk_bf16_f32 v51, v82, v83
    ds_write_b128 v6, v[48:51] offset:28672
    s_add_u32 s54, s52, 1
    s_and_b32 s54, s54, 7
    s_mul_i32 s55, s54, 196608
    s_add_u32 m0, s53, 24576
    s_add_u32 s50, s56, s55
    buffer_load_dwordx4 v7, s[16:19], s50 offen lds
    s_add_u32 m0, s53, 25600
    s_add_u32 s50, s57, s55
    buffer_load_dwordx4 v7, s[16:19], s50 offen lds
    s_add_u32 m0, s53, 26624
    s_add_u32 s50, s58, s55
    buffer_load_dwordx4 v7, s[16:19], s50 offen lds
    s_add_u32 m0, s53, 27648
    s_add_u32 s50, s59, s55
    buffer_load_dwordx4 v7, s[16:19], s50 offen lds
    s_add_u32 m0, s53, 28672
    s_add_u32 s50, s60, s55
    buffer_load_dwordx4 v7, s[16:19], s50 offen lds
    s_add_u32 m0, s53, 29696
    s_add_u32 s50, s61, s55
    buffer_load_dwordx4 v7, s[16:19], s50 offen lds
    s_and_b32 s62, s3, 1
    s_lshr_b32 s63, s3, 1
    v_and_b32 v84, 31, v1
    v_lshrrev_b32 v85, 5, v1
    s_lshl_b32 s50, s62, 15
    v_or_b32 v86, 0, v85
    v_xor_b32 v86, v86, v84
    v_lshlrev_b32 v86, 4, v86
    v_lshl_add_u32 v86, v85, 9, v86
    v_add_u32 v92, s50, v86
    v_or_b32 v86, 2, v85
    v_xor_b32 v86, v86, v84
    v_lshlrev_b32 v86, 4, v86
    v_lshl_add_u32 v86, v85, 9, v86
    v_add_u32 v93, s50, v86
    v_or_b32 v86, 4, v85
    v_xor_b32 v86, v86, v84
    v_lshlrev_b32 v86, 4, v86
    v_lshl_add_u32 v86, v85, 9, v86
    v_add_u32 v94, s50, v86
    v_or_b32 v86, 6, v85
    v_xor_b32 v86, v86, v84
    v_lshlrev_b32 v86, 4, v86
    v_lshl_add_u32 v86, v85, 9, v86
    v_add_u32 v95, s50, v86
    v_bfe_u32 v86, v1, 4, 1
    s_lshl_b32 s50, s63, 1
    v_or_b32 v86, s50, v86
    v_bfe_u32 v87, v1, 3, 1
    v_lshlrev_b32 v87, 1, v87
    v_xor_b32 v86, v86, v87
    v_lshlrev_b32 v86, 5, v86
    v_lshl_add_u32 v86, v85, 10, v86
    v_bfe_u32 v87, v1, 2, 2
    v_lshl_add_u32 v86, v87, 7, v86
    v_and_b32 v87, 3, v1
    v_lshl_add_u32 v86, v87, 3, v86
    v_add_u32 v100, 65536, v86
    v_add_u32 v101, 114688, v86
    v_mov_b32 v104, 0
    v_mov_b32 v120, 0
    v_mov_b32 v136, 0
    v_mov_b32 v105, 0
    v_mov_b32 v121, 0
    v_mov_b32 v137, 0
    v_mov_b32 v106, 0
    v_mov_b32 v122, 0
    v_mov_b32 v138, 0
    v_mov_b32 v107, 0
    v_mov_b32 v123, 0
    v_mov_b32 v139, 0
    v_mov_b32 v108, 0
    v_mov_b32 v124, 0
    v_mov_b32 v140, 0
    v_mov_b32 v109, 0
    v_mov_b32 v125, 0
    v_mov_b32 v141, 0
    v_mov_b32 v110, 0
    v_mov_b32 v126, 0
    v_mov_b32 v142, 0
    v_mov_b32 v111, 0
    v_mov_b32 v127, 0
    v_mov_b32 v143, 0
    v_mov_b32 v112, 0
    v_mov_b32 v128, 0
    v_mov_b32 v144, 0
    v_mov_b32 v113, 0
    v_mov_b32 v129, 0
    v_mov_b32 v145, 0
    v_mov_b32 v114, 0
    v_mov_b32 v130, 0
    v_mov_b32 v146, 0
    v_mov_b32 v115, 0
    v_mov_b32 v131, 0
    v_mov_b32 v147, 0
    v_mov_b32 v116, 0
    v_mov_b32 v132, 0
    v_mov_b32 v148, 0
    v_mov_b32 v117, 0
    v_mov_b32 v133, 0
    v_mov_b32 v149, 0
    v_mov_b32 v118, 0
    v_mov_b32 v134, 0
    v_mov_b32 v150, 0
    v_mov_b32 v119, 0
    v_mov_b32 v135, 0
    v_mov_b32 v151, 0
    s_add_u32 s64, s52, 0
    s_and_b32 s64, s64, 7
    s_lshl_b32 s64, s64, 12
    v_add_u32 v96, s64, v92
    v_add_u32 v97, s64, v93
    v_add_u32 v98, s64, v94
    v_add_u32 v99, s64, v95
    s_waitcnt lgkmcnt(0)
    s_barrier
    ds_read_b128 v[152:155], v96 offset:0
    ds_read_b64_tr_b16 v[168:169], v100 offset:0
    ds_read_b64_tr_b16 v[170:171], v100 offset:512
    ds_read_b64_tr_b16 v[172:173], v100 offset:8192
    ds_read_b64_tr_b16 v[174:175], v100 offset:8704
    ds_read_b64_tr_b16 v[176:177], v100 offset:16384
    ds_read_b64_tr_b16 v[178:179], v100 offset:16896
    ds_read_b128 v[156:159], v97 offset:1024
    ds_read_b64_tr_b16 v[180:181], v100 offset:2048
    ds_read_b64_tr_b16 v[182:183], v100 offset:2560
    ds_read_b64_tr_b16 v[184:185], v100 offset:10240
    ds_read_b64_tr_b16 v[186:187], v100 offset:10752
    ds_read_b64_tr_b16 v[188:189], v100 offset:18432
    ds_read_b64_tr_b16 v[190:191], v100 offset:18944
    s_waitcnt lgkmcnt(7)
    v_mfma_f32_32x32x16_bf16 v[104:119], v[168:171], v[152:155], v[104:119]
    ds_read_b128 v[160:163], v98 offset:2048
    ds_read_b64_tr_b16 v[192:193], v100 offset:4096
    ds_read_b64_tr_b16 v[194:195], v100 offset:4608
    ds_read_b64_tr_b16 v[196:197], v100 offset:12288
    ds_read_b64_tr_b16 v[198:199], v100 offset:12800
    v_mfma_f32_32x32x16_bf16 v[120:135], v[172:175], v[152:155], v[120:135]
    ds_read_b64_tr_b16 v[200:201], v100 offset:20480
    ds_read_b64_tr_b16 v[202:203], v100 offset:20992
    ds_read_b128 v[164:167], v99 offset:3072
    ds_read_b64_tr_b16 v[204:205], v100 offset:6144
    ds_read_b64_tr_b16 v[206:207], v100 offset:6656
    v_mfma_f32_32x32x16_bf16 v[136:151], v[152:155], v[176:179], v[136:151]
    ds_read_b64_tr_b16 v[208:209], v100 offset:14336
    ds_read_b64_tr_b16 v[210:211], v100 offset:14848
    ds_read_b64_tr_b16 v[212:213], v100 offset:22528
    ds_read_b64_tr_b16 v[214:215], v100 offset:23040
    s_waitcnt lgkmcnt(14)
    v_mfma_f32_32x32x16_bf16 v[104:119], v[180:183], v[156:159], v[104:119]
    v_mfma_f32_32x32x16_bf16 v[120:135], v[184:187], v[156:159], v[120:135]
    v_mfma_f32_32x32x16_bf16 v[136:151], v[156:159], v[188:191], v[136:151]
    s_waitcnt vmcnt(0) lgkmcnt(0)
    s_barrier
    s_add_u32 s64, s52, 1
    s_and_b32 s64, s64, 7
    s_lshl_b32 s64, s64, 12
    v_add_u32 v96, s64, v92
    v_add_u32 v97, s64, v93
    v_add_u32 v98, s64, v94
    v_add_u32 v99, s64, v95
    v_mfma_f32_32x32x16_bf16 v[104:119], v[192:195], v[160:163], v[104:119]
    ds_read_b128 v[152:155], v96 offset:0
    ds_read_b64_tr_b16 v[168:169], v100 offset:24576
    ds_read_b64_tr_b16 v[170:171], v100 offset:25088
    ds_read_b64_tr_b16 v[172:173], v100 offset:32768
    ds_read_b64_tr_b16 v[174:175], v100 offset:33280
    v_mfma_f32_32x32x16_bf16 v[120:135], v[196:199], v[160:163], v[120:135]
    ds_read_b64_tr_b16 v[176:177], v100 offset:40960
    ds_read_b64_tr_b16 v[178:179], v100 offset:41472
    ds_read_b128 v[156:159], v97 offset:1024
    ds_read_b64_tr_b16 v[180:181], v100 offset:26624
    ds_read_b64_tr_b16 v[182:183], v100 offset:27136
    v_mfma_f32_32x32x16_bf16 v[136:151], v[160:163], v[200:203], v[136:151]
    ds_read_b64_tr_b16 v[184:185], v100 offset:34816
    ds_read_b64_tr_b16 v[186:187], v100 offset:35328
    ds_read_b64_tr_b16 v[188:189], v100 offset:43008
    ds_read_b64_tr_b16 v[190:191], v100 offset:43520
    s_waitcnt lgkmcnt(14)
    v_mfma_f32_32x32x16_bf16 v[104:119], v[204:207], v[164:167], v[104:119]
    v_mfma_f32_32x32x16_bf16 v[120:135], v[208:211], v[164:167], v[120:135]
    v_mfma_f32_32x32x16_bf16 v[136:151], v[164:167], v[212:215], v[136:151]
    s_cmp_lg_u32 s3, 3
    s_cbranch_scc1 L_sequential_preLN__softmax_full_mha__swiglu_ffn__prompt_nocnt_8
    s_waitcnt vmcnt(0)
    s_and_b32 s7, s2, 63
    s_lshl_b32 s7, s7, 2
    v_mov_b32 v16, 1
    v_mov_b32 v17, 0
    s_mov_b64 exec, 1
    buffer_atomic_add v16, v17, s[40:43], s7 offen sc1
    s_mov_b64 exec, -1
L_sequential_preLN__softmax_full_mha__swiglu_ffn__prompt_nocnt_8:
    s_waitcnt lgkmcnt(7)
    v_mfma_f32_32x32x16_bf16 v[104:119], v[168:171], v[152:155], v[104:119]
    ds_read_b128 v[160:163], v98 offset:2048
    ds_read_b64_tr_b16 v[192:193], v100 offset:28672
    ds_read_b64_tr_b16 v[194:195], v100 offset:29184
    ds_read_b64_tr_b16 v[196:197], v100 offset:36864
    ds_read_b64_tr_b16 v[198:199], v100 offset:37376
    v_mfma_f32_32x32x16_bf16 v[120:135], v[172:175], v[152:155], v[120:135]
    ds_read_b64_tr_b16 v[200:201], v100 offset:45056
    ds_read_b64_tr_b16 v[202:203], v100 offset:45568
    ds_read_b128 v[164:167], v99 offset:3072
    ds_read_b64_tr_b16 v[204:205], v100 offset:30720
    ds_read_b64_tr_b16 v[206:207], v100 offset:31232
    v_mfma_f32_32x32x16_bf16 v[136:151], v[152:155], v[176:179], v[136:151]
    ds_read_b64_tr_b16 v[208:209], v100 offset:38912
    ds_read_b64_tr_b16 v[210:211], v100 offset:39424
    ds_read_b64_tr_b16 v[212:213], v100 offset:47104
    ds_read_b64_tr_b16 v[214:215], v100 offset:47616
    s_waitcnt lgkmcnt(14)
    v_mfma_f32_32x32x16_bf16 v[104:119], v[180:183], v[156:159], v[104:119]
    v_mfma_f32_32x32x16_bf16 v[120:135], v[184:187], v[156:159], v[120:135]
    v_mfma_f32_32x32x16_bf16 v[136:151], v[156:159], v[188:191], v[136:151]
    s_waitcnt lgkmcnt(0)
    s_barrier
    s_add_u32 s64, s52, 2
    s_and_b32 s64, s64, 7
    s_lshl_b32 s64, s64, 12
    v_add_u32 v96, s64, v92
    v_add_u32 v97, s64, v93
    v_add_u32 v98, s64, v94
    v_add_u32 v99, s64, v95
    v_mfma_f32_32x32x16_bf16 v[104:119], v[192:195], v[160:163], v[104:119]
    ds_read_b128 v[152:155], v96 offset:0
    ds_read_b64_tr_b16 v[168:169], v101 offset:0
    ds_read_b64_tr_b16 v[170:171], v101 offset:512
    ds_read_b64_tr_b16 v[172:173], v101 offset:8192
    ds_read_b64_tr_b16 v[174:175], v101 offset:8704
    v_mfma_f32_32x32x16_bf16 v[120:135], v[196:199], v[160:163], v[120:135]
    ds_read_b64_tr_b16 v[176:177], v101 offset:16384
    ds_read_b64_tr_b16 v[178:179], v101 offset:16896
    ds_read_b128 v[156:159], v97 offset:1024
    ds_read_b64_tr_b16 v[180:181], v101 offset:2048
    ds_read_b64_tr_b16 v[182:183], v101 offset:2560
    v_mfma_f32_32x32x16_bf16 v[136:151], v[160:163], v[200:203], v[136:151]
    ds_read_b64_tr_b16 v[184:185], v101 offset:10240
    ds_read_b64_tr_b16 v[186:187], v101 offset:10752
    ds_read_b64_tr_b16 v[188:189], v101 offset:18432
    ds_read_b64_tr_b16 v[190:191], v101 offset:18944
    s_waitcnt lgkmcnt(14)
    v_mfma_f32_32x32x16_bf16 v[104:119], v[204:207], v[164:167], v[104:119]
    v_mfma_f32_32x32x16_bf16 v[120:135], v[208:211], v[164:167], v[120:135]
    v_mfma_f32_32x32x16_bf16 v[136:151], v[164:167], v[212:215], v[136:151]
    s_waitcnt lgkmcnt(7)
    v_mfma_f32_32x32x16_bf16 v[104:119], v[168:171], v[152:155], v[104:119]
    ds_read_b128 v[160:163], v98 offset:2048
    ds_read_b64_tr_b16 v[192:193], v101 offset:4096
    ds_read_b64_tr_b16 v[194:195], v101 offset:4608
    ds_read_b64_tr_b16 v[196:197], v101 offset:12288
    ds_read_b64_tr_b16 v[198:199], v101 offset:12800
    v_mfma_f32_32x32x16_bf16 v[120:135], v[172:175], v[152:155], v[120:135]
    ds_read_b64_tr_b16 v[200:201], v101 offset:20480
    ds_read_b64_tr_b16 v[202:203], v101 offset:20992
    ds_read_b128 v[164:167], v99 offset:3072
    ds_read_b64_tr_b16 v[204:205], v101 offset:6144
    ds_read_b64_tr_b16 v[206:207], v101 offset:6656
    v_mfma_f32_32x32x16_bf16 v[136:151], v[152:155], v[176:179], v[136:151]
    ds_read_b64_tr_b16 v[208:209], v101 offset:14336
    ds_read_b64_tr_b16 v[210:211], v101 offset:14848
    ds_read_b64_tr_b16 v[212:213], v101 offset:22528
    ds_read_b64_tr_b16 v[214:215], v101 offset:23040
    s_waitcnt lgkmcnt(14)
    v_mfma_f32_32x32x16_bf16 v[104:119], v[180:183], v[156:159], v[104:119]
    v_mfma_f32_32x32x16_bf16 v[120:135], v[184:187], v[156:159], v[120:135]
    v_mfma_f32_32x32x16_bf16 v[136:151], v[156:159], v[188:191], v[136:151]
    s_waitcnt lgkmcnt(0)
    s_barrier
    s_add_u32 s64, s52, 3
    s_and_b32 s64, s64, 7
    s_lshl_b32 s64, s64, 12
    v_add_u32 v96, s64, v92
    v_add_u32 v97, s64, v93
    v_add_u32 v98, s64, v94
    v_add_u32 v99, s64, v95
    v_mfma_f32_32x32x16_bf16 v[104:119], v[192:195], v[160:163], v[104:119]
    ds_read_b128 v[152:155], v96 offset:0
    ds_read_b64_tr_b16 v[168:169], v101 offset:24576
    ds_read_b64_tr_b16 v[170:171], v101 offset:25088
    ds_read_b64_tr_b16 v[172:173], v101 offset:32768
    ds_read_b64_tr_b16 v[174:175], v101 offset:33280
    v_mfma_f32_32x32x16_bf16 v[120:135], v[196:199], v[160:163], v[120:135]
    ds_read_b64_tr_b16 v[176:177], v101 offset:40960
    ds_read_b64_tr_b16 v[178:179], v101 offset:41472
    ds_read_b128 v[156:159], v97 offset:1024
    ds_read_b64_tr_b16 v[180:181], v101 offset:26624
    ds_read_b64_tr_b16 v[182:183], v101 offset:27136
    v_mfma_f32_32x32x16_bf16 v[136:151], v[160:163], v[200:203], v[136:151]
    ds_read_b64_tr_b16 v[184:185], v101 offset:34816
    ds_read_b64_tr_b16 v[186:187], v101 offset:35328
    ds_read_b64_tr_b16 v[188:189], v101 offset:43008
    ds_read_b64_tr_b16 v[190:191], v101 offset:43520
    s_waitcnt lgkmcnt(14)
    v_mfma_f32_32x32x16_bf16 v[104:119], v[204:207], v[164:167], v[104:119]
    v_mfma_f32_32x32x16_bf16 v[120:135], v[208:211], v[164:167], v[120:135]
    v_mfma_f32_32x32x16_bf16 v[136:151], v[164:167], v[212:215], v[136:151]
    s_waitcnt lgkmcnt(7)
    v_mfma_f32_32x32x16_bf16 v[104:119], v[168:171], v[152:155], v[104:119]
    ds_read_b128 v[160:163], v98 offset:2048
    ds_read_b64_tr_b16 v[192:193], v101 offset:28672
    ds_read_b64_tr_b16 v[194:195], v101 offset:29184
    ds_read_b64_tr_b16 v[196:197], v101 offset:36864
    ds_read_b64_tr_b16 v[198:199], v101 offset:37376
    v_mfma_f32_32x32x16_bf16 v[120:135], v[172:175], v[152:155], v[120:135]
    ds_read_b64_tr_b16 v[200:201], v101 offset:45056
    ds_read_b64_tr_b16 v[202:203], v101 offset:45568
    ds_read_b128 v[164:167], v99 offset:3072
    ds_read_b64_tr_b16 v[204:205], v101 offset:30720
    ds_read_b64_tr_b16 v[206:207], v101 offset:31232
    v_mfma_f32_32x32x16_bf16 v[136:151], v[152:155], v[176:179], v[136:151]
    ds_read_b64_tr_b16 v[208:209], v101 offset:38912
    ds_read_b64_tr_b16 v[210:211], v101 offset:39424
    ds_read_b64_tr_b16 v[212:213], v101 offset:47104
    ds_read_b64_tr_b16 v[214:215], v101 offset:47616
    s_waitcnt lgkmcnt(14)
    v_mfma_f32_32x32x16_bf16 v[104:119], v[180:183], v[156:159], v[104:119]
    v_mfma_f32_32x32x16_bf16 v[120:135], v[184:187], v[156:159], v[120:135]
    v_mfma_f32_32x32x16_bf16 v[136:151], v[156:159], v[188:191], v[136:151]
    s_waitcnt lgkmcnt(0)
    s_barrier
    s_add_u32 s64, s52, 4
    s_and_b32 s64, s64, 7
    s_lshl_b32 s64, s64, 12
    v_add_u32 v96, s64, v92
    v_add_u32 v97, s64, v93
    v_add_u32 v98, s64, v94
    v_add_u32 v99, s64, v95
    v_mfma_f32_32x32x16_bf16 v[104:119], v[192:195], v[160:163], v[104:119]
    ds_read_b128 v[152:155], v96 offset:0
    ds_read_b64_tr_b16 v[168:169], v100 offset:0
    ds_read_b64_tr_b16 v[170:171], v100 offset:512
    ds_read_b64_tr_b16 v[172:173], v100 offset:8192
    ds_read_b64_tr_b16 v[174:175], v100 offset:8704
    v_mfma_f32_32x32x16_bf16 v[120:135], v[196:199], v[160:163], v[120:135]
    ds_read_b64_tr_b16 v[176:177], v100 offset:16384
    ds_read_b64_tr_b16 v[178:179], v100 offset:16896
    ds_read_b128 v[156:159], v97 offset:1024
    ds_read_b64_tr_b16 v[180:181], v100 offset:2048
    ds_read_b64_tr_b16 v[182:183], v100 offset:2560
    v_mfma_f32_32x32x16_bf16 v[136:151], v[160:163], v[200:203], v[136:151]
    ds_read_b64_tr_b16 v[184:185], v100 offset:10240
    ds_read_b64_tr_b16 v[186:187], v100 offset:10752
    ds_read_b64_tr_b16 v[188:189], v100 offset:18432
    ds_read_b64_tr_b16 v[190:191], v100 offset:18944
    s_waitcnt lgkmcnt(14)
    v_mfma_f32_32x32x16_bf16 v[104:119], v[204:207], v[164:167], v[104:119]
    v_mfma_f32_32x32x16_bf16 v[120:135], v[208:211], v[164:167], v[120:135]
    v_mfma_f32_32x32x16_bf16 v[136:151], v[164:167], v[212:215], v[136:151]
    s_waitcnt lgkmcnt(7)
    v_mfma_f32_32x32x16_bf16 v[104:119], v[168:171], v[152:155], v[104:119]
    ds_read_b128 v[160:163], v98 offset:2048
    ds_read_b64_tr_b16 v[192:193], v100 offset:4096
    ds_read_b64_tr_b16 v[194:195], v100 offset:4608
    ds_read_b64_tr_b16 v[196:197], v100 offset:12288
    ds_read_b64_tr_b16 v[198:199], v100 offset:12800
    v_mfma_f32_32x32x16_bf16 v[120:135], v[172:175], v[152:155], v[120:135]
    ds_read_b64_tr_b16 v[200:201], v100 offset:20480
    ds_read_b64_tr_b16 v[202:203], v100 offset:20992
    ds_read_b128 v[164:167], v99 offset:3072
    ds_read_b64_tr_b16 v[204:205], v100 offset:6144
    ds_read_b64_tr_b16 v[206:207], v100 offset:6656
    v_mfma_f32_32x32x16_bf16 v[136:151], v[152:155], v[176:179], v[136:151]
    ds_read_b64_tr_b16 v[208:209], v100 offset:14336
    ds_read_b64_tr_b16 v[210:211], v100 offset:14848
    ds_read_b64_tr_b16 v[212:213], v100 offset:22528
    ds_read_b64_tr_b16 v[214:215], v100 offset:23040
    s_waitcnt lgkmcnt(14)
    v_mfma_f32_32x32x16_bf16 v[104:119], v[180:183], v[156:159], v[104:119]
    v_mfma_f32_32x32x16_bf16 v[120:135], v[184:187], v[156:159], v[120:135]
    v_mfma_f32_32x32x16_bf16 v[136:151], v[156:159], v[188:191], v[136:151]
    s_waitcnt lgkmcnt(0)
    s_barrier
    s_add_u32 s64, s52, 5
    s_and_b32 s64, s64, 7
    s_lshl_b32 s64, s64, 12
    v_add_u32 v96, s64, v92
    v_add_u32 v97, s64, v93
    v_add_u32 v98, s64, v94
    v_add_u32 v99, s64, v95
    v_mfma_f32_32x32x16_bf16 v[104:119], v[192:195], v[160:163], v[104:119]
    ds_read_b128 v[152:155], v96 offset:0
    ds_read_b64_tr_b16 v[168:169], v100 offset:24576
    ds_read_b64_tr_b16 v[170:171], v100 offset:25088
    ds_read_b64_tr_b16 v[172:173], v100 offset:32768
    ds_read_b64_tr_b16 v[174:175], v100 offset:33280
    v_mfma_f32_32x32x16_bf16 v[120:135], v[196:199], v[160:163], v[120:135]
    ds_read_b64_tr_b16 v[176:177], v100 offset:40960
    ds_read_b64_tr_b16 v[178:179], v100 offset:41472
    ds_read_b128 v[156:159], v97 offset:1024
    ds_read_b64_tr_b16 v[180:181], v100 offset:26624
    ds_read_b64_tr_b16 v[182:183], v100 offset:27136
    v_mfma_f32_32x32x16_bf16 v[136:151], v[160:163], v[200:203], v[136:151]
    ds_read_b64_tr_b16 v[184:185], v100 offset:34816
    ds_read_b64_tr_b16 v[186:187], v100 offset:35328
    ds_read_b64_tr_b16 v[188:189], v100 offset:43008
    ds_read_b64_tr_b16 v[190:191], v100 offset:43520
    s_waitcnt lgkmcnt(14)
    v_mfma_f32_32x32x16_bf16 v[104:119], v[204:207], v[164:167], v[104:119]
    v_mfma_f32_32x32x16_bf16 v[120:135], v[208:211], v[164:167], v[120:135]
    v_mfma_f32_32x32x16_bf16 v[136:151], v[164:167], v[212:215], v[136:151]
    s_waitcnt lgkmcnt(7)
    v_mfma_f32_32x32x16_bf16 v[104:119], v[168:171], v[152:155], v[104:119]
    ds_read_b128 v[160:163], v98 offset:2048
    ds_read_b64_tr_b16 v[192:193], v100 offset:28672
    ds_read_b64_tr_b16 v[194:195], v100 offset:29184
    ds_read_b64_tr_b16 v[196:197], v100 offset:36864
    ds_read_b64_tr_b16 v[198:199], v100 offset:37376
    v_mfma_f32_32x32x16_bf16 v[120:135], v[172:175], v[152:155], v[120:135]
    ds_read_b64_tr_b16 v[200:201], v100 offset:45056
    ds_read_b64_tr_b16 v[202:203], v100 offset:45568
    ds_read_b128 v[164:167], v99 offset:3072
    ds_read_b64_tr_b16 v[204:205], v100 offset:30720
    ds_read_b64_tr_b16 v[206:207], v100 offset:31232
    v_mfma_f32_32x32x16_bf16 v[136:151], v[152:155], v[176:179], v[136:151]
    ds_read_b64_tr_b16 v[208:209], v100 offset:38912
    ds_read_b64_tr_b16 v[210:211], v100 offset:39424
    ds_read_b64_tr_b16 v[212:213], v100 offset:47104
    ds_read_b64_tr_b16 v[214:215], v100 offset:47616
    s_waitcnt lgkmcnt(14)
    v_mfma_f32_32x32x16_bf16 v[104:119], v[180:183], v[156:159], v[104:119]
    v_mfma_f32_32x32x16_bf16 v[120:135], v[184:187], v[156:159], v[120:135]
    v_mfma_f32_32x32x16_bf16 v[136:151], v[156:159], v[188:191], v[136:151]
    s_waitcnt lgkmcnt(0)
    s_barrier
    s_add_u32 s64, s52, 6
    s_and_b32 s64, s64, 7
    s_lshl_b32 s64, s64, 12
    v_add_u32 v96, s64, v92
    v_add_u32 v97, s64, v93
    v_add_u32 v98, s64, v94
    v_add_u32 v99, s64, v95
    v_mfma_f32_32x32x16_bf16 v[104:119], v[192:195], v[160:163], v[104:119]
    ds_read_b128 v[152:155], v96 offset:0
    ds_read_b64_tr_b16 v[168:169], v101 offset:0
    ds_read_b64_tr_b16 v[170:171], v101 offset:512
    ds_read_b64_tr_b16 v[172:173], v101 offset:8192
    ds_read_b64_tr_b16 v[174:175], v101 offset:8704
    v_mfma_f32_32x32x16_bf16 v[120:135], v[196:199], v[160:163], v[120:135]
    ds_read_b64_tr_b16 v[176:177], v101 offset:16384
    ds_read_b64_tr_b16 v[178:179], v101 offset:16896
    ds_read_b128 v[156:159], v97 offset:1024
    ds_read_b64_tr_b16 v[180:181], v101 offset:2048
    ds_read_b64_tr_b16 v[182:183], v101 offset:2560
    v_mfma_f32_32x32x16_bf16 v[136:151], v[160:163], v[200:203], v[136:151]
    ds_read_b64_tr_b16 v[184:185], v101 offset:10240
    ds_read_b64_tr_b16 v[186:187], v101 offset:10752
    ds_read_b64_tr_b16 v[188:189], v101 offset:18432
    ds_read_b64_tr_b16 v[190:191], v101 offset:18944
    s_waitcnt lgkmcnt(14)
    v_mfma_f32_32x32x16_bf16 v[104:119], v[204:207], v[164:167], v[104:119]
    v_mfma_f32_32x32x16_bf16 v[120:135], v[208:211], v[164:167], v[120:135]
    v_mfma_f32_32x32x16_bf16 v[136:151], v[164:167], v[212:215], v[136:151]
    s_cmp_lg_u32 s3, 0
    s_cbranch_scc1 L_sequential_preLN__softmax_full_mha__swiglu_ffn__prompt_noarr_9
    v_lshlrev_b32 v17, 2, v1
    buffer_load_dword v16, v17, s[40:43], 0 offen sc1
L_sequential_preLN__softmax_full_mha__swiglu_ffn__prompt_noarr_9:
    s_waitcnt lgkmcnt(7)
    v_mfma_f32_32x32x16_bf16 v[104:119], v[168:171], v[152:155], v[104:119]
    ds_read_b128 v[160:163], v98 offset:2048
    ds_read_b64_tr_b16 v[192:193], v101 offset:4096
    ds_read_b64_tr_b16 v[194:195], v101 offset:4608
    ds_read_b64_tr_b16 v[196:197], v101 offset:12288
    ds_read_b64_tr_b16 v[198:199], v101 offset:12800
    v_mfma_f32_32x32x16_bf16 v[120:135], v[172:175], v[152:155], v[120:135]
    ds_read_b64_tr_b16 v[200:201], v101 offset:20480
    ds_read_b64_tr_b16 v[202:203], v101 offset:20992
    ds_read_b128 v[164:167], v99 offset:3072
    ds_read_b64_tr_b16 v[204:205], v101 offset:6144
    ds_read_b64_tr_b16 v[206:207], v101 offset:6656
    v_mfma_f32_32x32x16_bf16 v[136:151], v[152:155], v[176:179], v[136:151]
    ds_read_b64_tr_b16 v[208:209], v101 offset:14336
    ds_read_b64_tr_b16 v[210:211], v101 offset:14848
    ds_read_b64_tr_b16 v[212:213], v101 offset:22528
    ds_read_b64_tr_b16 v[214:215], v101 offset:23040
    s_waitcnt lgkmcnt(14)
    v_mfma_f32_32x32x16_bf16 v[104:119], v[180:183], v[156:159], v[104:119]
    v_mfma_f32_32x32x16_bf16 v[120:135], v[184:187], v[156:159], v[120:135]
    v_mfma_f32_32x32x16_bf16 v[136:151], v[156:159], v[188:191], v[136:151]
    s_waitcnt lgkmcnt(0)
    s_barrier
    s_add_u32 s64, s52, 7
    s_and_b32 s64, s64, 7
    s_lshl_b32 s64, s64, 12
    v_add_u32 v96, s64, v92
    v_add_u32 v97, s64, v93
    v_add_u32 v98, s64, v94
    v_add_u32 v99, s64, v95
    v_mfma_f32_32x32x16_bf16 v[104:119], v[192:195], v[160:163], v[104:119]
    ds_read_b128 v[152:155], v96 offset:0
    ds_read_b64_tr_b16 v[168:169], v101 offset:24576
    ds_read_b64_tr_b16 v[170:171], v101 offset:25088
    ds_read_b64_tr_b16 v[172:173], v101 offset:32768
    ds_read_b64_tr_b16 v[174:175], v101 offset:33280
    v_mfma_f32_32x32x16_bf16 v[120:135], v[196:199], v[160:163], v[120:135]
    ds_read_b64_tr_b16 v[176:177], v101 offset:40960
    ds_read_b64_tr_b16 v[178:179], v101 offset:41472
    ds_read_b128 v[156:159], v97 offset:1024
    ds_read_b64_tr_b16 v[180:181], v101 offset:26624
    ds_read_b64_tr_b16 v[182:183], v101 offset:27136
    v_mfma_f32_32x32x16_bf16 v[136:151], v[160:163], v[200:203], v[136:151]
    ds_read_b64_tr_b16 v[184:185], v101 offset:34816
    ds_read_b64_tr_b16 v[186:187], v101 offset:35328
    ds_read_b64_tr_b16 v[188:189], v101 offset:43008
    ds_read_b64_tr_b16 v[190:191], v101 offset:43520
    s_waitcnt lgkmcnt(14)
    v_mfma_f32_32x32x16_bf16 v[104:119], v[204:207], v[164:167], v[104:119]
    v_mfma_f32_32x32x16_bf16 v[120:135], v[208:211], v[164:167], v[120:135]
    v_mfma_f32_32x32x16_bf16 v[136:151], v[164:167], v[212:215], v[136:151]
    s_waitcnt lgkmcnt(7)
    v_mfma_f32_32x32x16_bf16 v[104:119], v[168:171], v[152:155], v[104:119]
    ds_read_b128 v[160:163], v98 offset:2048
    ds_read_b64_tr_b16 v[192:193], v101 offset:28672
    ds_read_b64_tr_b16 v[194:195], v101 offset:29184
    ds_read_b64_tr_b16 v[196:197], v101 offset:36864
    ds_read_b64_tr_b16 v[198:199], v101 offset:37376
    v_mfma_f32_32x32x16_bf16 v[120:135], v[172:175], v[152:155], v[120:135]
    ds_read_b64_tr_b16 v[200:201], v101 offset:45056
    ds_read_b64_tr_b16 v[202:203], v101 offset:45568
    ds_read_b128 v[164:167], v99 offset:3072
    ds_read_b64_tr_b16 v[204:205], v101 offset:30720
    ds_read_b64_tr_b16 v[206:207], v101 offset:31232
    v_mfma_f32_32x32x16_bf16 v[136:151], v[152:155], v[176:179], v[136:151]
    ds_read_b64_tr_b16 v[208:209], v101 offset:38912
    ds_read_b64_tr_b16 v[210:211], v101 offset:39424
    ds_read_b64_tr_b16 v[212:213], v101 offset:47104
    ds_read_b64_tr_b16 v[214:215], v101 offset:47616
    s_waitcnt lgkmcnt(14)
    v_mfma_f32_32x32x16_bf16 v[104:119], v[180:183], v[156:159], v[104:119]
    v_mfma_f32_32x32x16_bf16 v[120:135], v[184:187], v[156:159], v[120:135]
    v_mfma_f32_32x32x16_bf16 v[136:151], v[156:159], v[188:191], v[136:151]
    s_waitcnt lgkmcnt(7)
    v_mfma_f32_32x32x16_bf16 v[104:119], v[192:195], v[160:163], v[104:119]
    v_mfma_f32_32x32x16_bf16 v[120:135], v[196:199], v[160:163], v[120:135]
    v_mfma_f32_32x32x16_bf16 v[136:151], v[160:163], v[200:203], v[136:151]
    s_waitcnt lgkmcnt(0)
    v_mfma_f32_32x32x16_bf16 v[104:119], v[204:207], v[164:167], v[104:119]
    v_mfma_f32_32x32x16_bf16 v[120:135], v[208:211], v[164:167], v[120:135]
    v_mfma_f32_32x32x16_bf16 v[136:151], v[164:167], v[212:215], v[136:151]
    s_lshl_b32 s65, s49, 2
    s_lshl_b32 s50, s63, 1
    s_add_u32 s65, s65, s50
    s_lshl_b32 s66, s48, 1
    s_add_u32 s66, s66, s62
    s_lshl_b32 s50, s65, 16
    s_lshl_b32 s51, s66, 10
    s_add_u32 s67, s50, s51
    s_mov_b32 s64, 0x3eb8aa3b
    s_nop 2
    v_cvt_pk_bf16_f32 v28, v120, v121
    v_cvt_pk_bf16_f32 v29, v122, v123
    v_cvt_pk_bf16_f32 v30, v124, v125
    v_cvt_pk_bf16_f32 v31, v126, v127
    v_cvt_pk_bf16_f32 v32, v128, v129
    v_cvt_pk_bf16_f32 v33, v130, v131
    v_cvt_pk_bf16_f32 v34, v132, v133
    v_cvt_pk_bf16_f32 v35, v134, v135
    s_cmp_lg_u32 s3, 0
    s_cbranch_scc1 L_sequential_preLN__softmax_full_mha__swiglu_ffn__prompt_noarr_10
    v_lshlrev_b32 v17, 2, v1
    s_waitcnt vmcnt(0)
    v_cmp_ne_u32 vcc, 4, v16
    s_cbranch_vccz L_sequential_preLN__softmax_full_mha__swiglu_ffn__prompt_arr_ok_11
    s_mov_b32 s45, 0
L_sequential_preLN__softmax_full_mha__swiglu_ffn__prompt_spin_12:
    s_add_u32 s45, s45, 1
    s_cmp_gt_u32 s45, 1048576
    s_cbranch_scc1 L_sequential_preLN__softmax_full_mha__swiglu_ffn__prompt_spin_out_13
    buffer_load_dword v16, v17, s[40:43], 0 offen sc1
    s_waitcnt vmcnt(0)
    v_cmp_ne_u32 vcc, 4, v16
    s_cbranch_vccnz L_sequential_preLN__softmax_full_mha__swiglu_ffn__prompt_spin_12
L_sequential_preLN__softmax_full_mha__swiglu_ffn__prompt_spin_out_13:
L_sequential_preLN__softmax_full_mha__swiglu_ffn__prompt_arr_ok_11:
L_sequential_preLN__softmax_full_mha__swiglu_ffn__prompt_noarr_10:
    s_add_u32 s50, s67, 2097152
    buffer_store_dwordx4 v[28:31], v2, s[8:11], s50 offen sc1
    s_add_u32 s50, s67, 2162688
    buffer_store_dwordx4 v[32:35], v2, s[8:11], s50 offen sc1
    v_cvt_pk_bf16_f32 v36, v136, v137
    v_cvt_pk_bf16_f32 v37, v138, v139
    v_cvt_pk_bf16_f32 v38, v140, v141
    v_cvt_pk_bf16_f32 v39, v142, v143
    v_cvt_pk_bf16_f32 v40, v144, v145
    v_cvt_pk_bf16_f32 v41, v146, v147
    v_cvt_pk_bf16_f32 v42, v148, v149
    v_cvt_pk_bf16_f32 v43, v150, v151
    v_bfe_u32 v84, v1, 4, 1
    v_lshlrev_b32 v84, 16, v84
    v_lshrrev_b32 v85, 5, v1
    v_lshl_add_u32 v84, v85, 8, v84
    v_and_b32 v85, 15, v1
    v_lshl_add_u32 v84, v85, 4, v84
    s_add_u32 s50, s67, 4194304
    buffer_store_dwordx4 v[36:39], v84, s[8:11], s50 offen offset:0 sc1
    buffer_store_dwordx4 v[40:43], v84, s[8:11], s50 offen offset:512 sc1
    v_mul_f32 v104, s64, v104
    v_mul_f32 v105, s64, v105
    v_mul_f32 v106, s64, v106
    v_mul_f32 v107, s64, v107
    v_mul_f32 v108, s64, v108
    v_mul_f32 v109, s64, v109
    v_mul_f32 v110, s64, v110
    v_mul_f32 v111, s64, v111
    v_mul_f32 v112, s64, v112
    v_mul_f32 v113, s64, v113
    v_mul_f32 v114, s64, v114
    v_mul_f32 v115, s64, v115
    v_mul_f32 v116, s64, v116
    v_mul_f32 v117, s64, v117
    v_mul_f32 v118, s64, v118
    v_mul_f32 v119, s64, v119
    v_cvt_pk_bf16_f32 v20, v104, v105
    v_cvt_pk_bf16_f32 v21, v106, v107
    v_cvt_pk_bf16_f32 v22, v108, v109
    v_cvt_pk_bf16_f32 v23, v110, v111
    v_cvt_pk_bf16_f32 v24, v112, v113
    v_cvt_pk_bf16_f32 v25, v114, v115
    v_cvt_pk_bf16_f32 v26, v116, v117
    v_cvt_pk_bf16_f32 v27, v118, v119
    s_add_u32 s50, s67, 0
    buffer_store_dwordx4 v[20:23], v2, s[8:11], s50 offen sc1
    s_add_u32 s50, s67, 65536
    buffer_store_dwordx4 v[24:27], v2, s[8:11], s50 offen sc1
    v_mul_f32 v52, v120, v120
    v_mul_f32 v53, v128, v128
    v_fmac_f32 v52, v121, v121
    v_fmac_f32 v53, v129, v129
    v_fmac_f32 v52, v122, v122
    v_fmac_f32 v53, v130, v130
    v_fmac_f32 v52, v123, v123
    v_fmac_f32 v53, v131, v131
    v_fmac_f32 v52, v124, v124
    v_fmac_f32 v53, v132, v132
    v_fmac_f32 v52, v125, v125
    v_fmac_f32 v53, v133, v133
    v_fmac_f32 v52, v126, v126
    v_fmac_f32 v53, v134, v134
    v_fmac_f32 v52, v127, v127
    v_fmac_f32 v53, v135, v135
    v_mov_b32 v54, v52
    v_mov_b32 v55, v53
    s_nop 1
    v_permlane32_swap_b32 v52, v54
    v_permlane32_swap_b32 v53, v55
    v_add_f32 v52, v52, v54
    v_add_f32 v53, v53, v55
    s_nop 1
    v_max_f32_dpp v52, v52, v52 quad_perm:[1,0,3,2] row_mask:0xf bank_mask:0xf
    v_max_f32_dpp v53, v53, v53 quad_perm:[1,0,3,2] row_mask:0xf bank_mask:0xf
    s_nop 1
    v_max_f32_dpp v52, v52, v52 quad_perm:[2,3,0,1] row_mask:0xf bank_mask:0xf
    v_max_f32_dpp v53, v53, v53 quad_perm:[2,3,0,1] row_mask:0xf bank_mask:0xf
    s_nop 1
    v_max_f32_dpp v52, v52, v52 row_half_mirror row_mask:0xf bank_mask:0xf
    v_max_f32_dpp v53, v53, v53 row_half_mirror row_mask:0xf bank_mask:0xf
    s_nop 1
    v_max_f32_dpp v52, v52, v52 row_mirror row_mask:0xf bank_mask:0xf
    v_max_f32_dpp v53, v53, v53 row_mirror row_mask:0xf bank_mask:0xf
    v_mov_b32 v54, v52
    v_mov_b32 v55, v52
    v_mov_b32 v56, v53
    v_mov_b32 v57, v53
    s_nop 1
    v_permlane16_swap_b32 v54, v55
    v_permlane16_swap_b32 v56, v57
    v_max_f32 v52, v54, v55
    v_max_f32 v53, v56, v57
    v_cmp_gt_u32 vcc, 32, v1
    s_lshl_b32 s50, s65, 13
    s_lshl_b32 s51, s66, 7
    v_cndmask_b32 v52, v53, v52, vcc
    s_add_u32 s50, s50, s51
    s_add_u32 s50, s50, 23068672
    v_lshrrev_b32 v58, 5, v1
    v_lshlrev_b32 v58, 13, v58
    v_and_b32 v59, 31, v1
    v_lshl_add_u32 v58, v59, 2, v58
    buffer_store_dword v52, v58, s[8:11], s50 offen sc1
    s_branch L_sequential_preLN__softmax_full_mha__swiglu_ffn__prompt_p1_done_5
L_sequential_preLN__softmax_full_mha__swiglu_ffn__prompt_p1_loader_4:
    s_sub_u32 s54, s3, 4
    s_mul_i32 s54, s54, 6
    s_lshl_b32 s53, s54, 10
    s_add_u32 s53, s53, 65536
    s_add_u32 s50, s54, 0
    s_lshr_b32 s51, s50, 3
    s_and_b32 s50, s50, 7
    s_mul_i32 s56, s50, 24576
    s_lshl_b32 s51, s51, 10
    s_add_u32 s56, s56, s51
    s_lshl_b32 s51, s49, 7
    s_add_u32 s56, s56, s51
    s_add_u32 s50, s54, 1
    s_lshr_b32 s51, s50, 3
    s_and_b32 s50, s50, 7
    s_mul_i32 s57, s50, 24576
    s_lshl_b32 s51, s51, 10
    s_add_u32 s57, s57, s51
    s_lshl_b32 s51, s49, 7
    s_add_u32 s57, s57, s51
    s_add_u32 s50, s54, 2
    s_lshr_b32 s51, s50, 3
    s_and_b32 s50, s50, 7
    s_mul_i32 s58, s50, 24576
    s_lshl_b32 s51, s51, 10
    s_add_u32 s58, s58, s51
    s_lshl_b32 s51, s49, 7
    s_add_u32 s58, s58, s51
    s_add_u32 s50, s54, 3
    s_lshr_b32 s51, s50, 3
    s_and_b32 s50, s50, 7
    s_mul_i32 s59, s50, 24576
    s_lshl_b32 s51, s51, 10
    s_add_u32 s59, s59, s51
    s_lshl_b32 s51, s49, 7
    s_add_u32 s59, s59, s51
    s_add_u32 s50, s54, 4
    s_lshr_b32 s51, s50, 3
    s_and_b32 s50, s50, 7
    s_mul_i32 s60, s50, 24576
    s_lshl_b32 s51, s51, 10
    s_add_u32 s60, s60, s51
    s_lshl_b32 s51, s49, 7
    s_add_u32 s60, s60, s51
    s_add_u32 s50, s54, 5
    s_lshr_b32 s51, s50, 3
    s_and_b32 s50, s50, 7
    s_mul_i32 s61, s50, 24576
    s_lshl_b32 s51, s51, 10
    s_add_u32 s61, s61, s51
    s_lshl_b32 s51, s49, 7
    s_add_u32 s61, s61, s51
    s_add_u32 s54, s52, 0
    s_and_b32 s54, s54, 7
    s_mul_i32 s55, s54, 196608
    s_add_u32 m0, s53, 0
    s_add_u32 s50, s56, s55
    buffer_load_dwordx4 v7, s[16:19], s50 offen lds
    s_add_u32 m0, s53, 1024
    s_add_u32 s50, s57, s55
    buffer_load_dwordx4 v7, s[16:19], s50 offen lds
    s_add_u32 m0, s53, 2048
    s_add_u32 s50, s58, s55
    buffer_load_dwordx4 v7, s[16:19], s50 offen lds
    s_add_u32 m0, s53, 3072
    s_add_u32 s50, s59, s55
    buffer_load_dwordx4 v7, s[16:19], s50 offen lds
    s_add_u32 m0, s53, 4096
    s_add_u32 s50, s60, s55
    buffer_load_dwordx4 v7, s[16:19], s50 offen lds
    s_add_u32 m0, s53, 5120
    s_add_u32 s50, s61, s55
    buffer_load_dwordx4 v7, s[16:19], s50 offen lds
    v_mov_b32 v54, 0x3f803f80
    s_waitcnt vmcnt(6)
    v_dot2_f32_bf16 v56, v20, v54, 0
    v_dot2_f32_bf16 v60, v20, v20, 0
    v_dot2_f32_bf16 v57, v21, v54, 0
    v_dot2_f32_bf16 v61, v21, v21, 0
    v_dot2_f32_bf16 v58, v22, v54, 0
    v_dot2_f32_bf16 v62, v22, v22, 0
    v_dot2_f32_bf16 v59, v23, v54, 0
    v_dot2_f32_bf16 v63, v23, v23, 0
    v_dot2_f32_bf16 v56, v24, v54, v56
    v_dot2_f32_bf16 v60, v24, v24, v60
    v_dot2_f32_bf16 v57, v25, v54, v57
    v_dot2_f32_bf16 v61, v25, v25, v61
    v_dot2_f32_bf16 v58, v26, v54, v58
    v_dot2_f32_bf16 v62, v26, v26, v62
    v_dot2_f32_bf16 v59, v27, v54, v59
    v_dot2_f32_bf16 v63, v27, v27, v63
    v_dot2_f32_bf16 v56, v28, v54, v56
    v_dot2_f32_bf16 v60, v28, v28, v60
    v_dot2_f32_bf16 v57, v29, v54, v57
    v_dot2_f32_bf16 v61, v29, v29, v61
    v_dot2_f32_bf16 v58, v30, v54, v58
    v_dot2_f32_bf16 v62, v30, v30, v62
    v_dot2_f32_bf16 v59, v31, v54, v59
    v_dot2_f32_bf16 v63, v31, v31, v63
    v_dot2_f32_bf16 v56, v32, v54, v56
    v_dot2_f32_bf16 v60, v32, v32, v60
    v_dot2_f32_bf16 v57, v33, v54, v57
    v_dot2_f32_bf16 v61, v33, v33, v61
    v_dot2_f32_bf16 v58, v34, v54, v58
    v_dot2_f32_bf16 v62, v34, v34, v62
    v_dot2_f32_bf16 v59, v35, v54, v59
    v_dot2_f32_bf16 v63, v35, v35, v63
    v_dot2_f32_bf16 v56, v36, v54, v56
    v_dot2_f32_bf16 v60, v36, v36, v60
    v_dot2_f32_bf16 v57, v37, v54, v57
    v_dot2_f32_bf16 v61, v37, v37, v61
    v_dot2_f32_bf16 v58, v38, v54, v58
    v_dot2_f32_bf16 v62, v38, v38, v62
    v_dot2_f32_bf16 v59, v39, v54, v59
    v_dot2_f32_bf16 v63, v39, v39, v63
    v_dot2_f32_bf16 v56, v40, v54, v56
    v_dot2_f32_bf16 v60, v40, v40, v60
    v_dot2_f32_bf16 v57, v41, v54, v57
    v_dot2_f32_bf16 v61, v41, v41, v61
    v_dot2_f32_bf16 v58, v42, v54, v58
    v_dot2_f32_bf16 v62, v42, v42, v62
    v_dot2_f32_bf16 v59, v43, v54, v59
    v_dot2_f32_bf16 v63, v43, v43, v63
    v_dot2_f32_bf16 v56, v44, v54, v56
    v_dot2_f32_bf16 v60, v44, v44, v60
    v_dot2_f32_bf16 v57, v45, v54, v57
    v_dot2_f32_bf16 v61, v45, v45, v61
    v_dot2_f32_bf16 v58, v46, v54, v58
    v_dot2_f32_bf16 v62, v46, v46, v62
    v_dot2_f32_bf16 v59, v47, v54, v59
    v_dot2_f32_bf16 v63, v47, v47, v63
    v_dot2_f32_bf16 v56, v48, v54, v56
    v_dot2_f32_bf16 v60, v48, v48, v60
    v_dot2_f32_bf16 v57, v49, v54, v57
    v_dot2_f32_bf16 v61, v49, v49, v61
    v_dot2_f32_bf16 v58, v50, v54, v58
    v_dot2_f32_bf16 v62, v50, v50, v62
    v_dot2_f32_bf16 v59, v51, v54, v59
    v_dot2_f32_bf16 v63, v51, v51, v63
    s_nop 2
    v_add_f32 v56, v56, v57
    v_add_f32 v60, v60, v61
    v_add_f32 v58, v58, v59
    v_add_f32 v62, v62, v63
    v_add_f32 v56, v56, v58
    v_add_f32 v60, v60, v62
    s_nop 1
    v_add_f32_dpp v56, v56, v56 quad_perm:[1,0,3,2] row_mask:0xf bank_mask:0xf
    v_add_f32_dpp v60, v60, v60 quad_perm:[1,0,3,2] row_mask:0xf bank_mask:0xf
    s_nop 1
    v_add_f32_dpp v56, v56, v56 quad_perm:[2,3,0,1] row_mask:0xf bank_mask:0xf
    v_add_f32_dpp v60, v60, v60 quad_perm:[2,3,0,1] row_mask:0xf bank_mask:0xf
    s_nop 1
    v_add_f32_dpp v56, v56, v56 row_half_mirror row_mask:0xf bank_mask:0xf
    v_add_f32_dpp v60, v60, v60 row_half_mirror row_mask:0xf bank_mask:0xf
    v_mul_f32 v56, 0x3b000000, v56
    v_mul_f32 v60, 0x3b000000, v60
    v_fma_f32 v60, -v56, v56, v60
    v_max_f32 v60, 0, v60
    v_add_f32 v60, 0x3727c5ac, v60
    v_rsq_f32 v64, v60
    s_nop 0
    v_mov_b32 v65, v64
    v_mul_f32 v66, -v56, v64
    v_mov_b32 v67, v66
    v_lshlrev_b32 v68, 16, v20
    v_and_b32 v69, 0xffff0000, v20
    v_lshlrev_b32 v70, 16, v21
    v_and_b32 v71, 0xffff0000, v21
    v_lshlrev_b32 v72, 16, v22
    v_and_b32 v73, 0xffff0000, v22
    v_lshlrev_b32 v74, 16, v23
    v_and_b32 v75, 0xffff0000, v23
    v_lshlrev_b32 v76, 16, v24
    v_and_b32 v77, 0xffff0000, v24
    v_lshlrev_b32 v78, 16, v25
    v_and_b32 v79, 0xffff0000, v25
    v_lshlrev_b32 v80, 16, v26
    v_and_b32 v81, 0xffff0000, v26
    v_lshlrev_b32 v82, 16, v27
    v_and_b32 v83, 0xffff0000, v27
    v_pk_fma_f32 v[68:69], v[68:69], v[64:65], v[66:67]
    v_pk_fma_f32 v[70:71], v[70:71], v[64:65], v[66:67]
    v_pk_fma_f32 v[72:73], v[72:73], v[64:65], v[66:67]
    v_pk_fma_f32 v[74:75], v[74:75], v[64:65], v[66:67]
    v_pk_fma_f32 v[76:77], v[76:77], v[64:65], v[66:67]
    v_pk_fma_f32 v[78:79], v[78:79], v[64:65], v[66:67]
    v_pk_fma_f32 v[80:81], v[80:81], v[64:65], v[66:67]
    v_pk_fma_f32 v[82:83], v[82:83], v[64:65], v[66:67]
    v_cvt_pk_bf16_f32 v20, v68, v69
    v_cvt_pk_bf16_f32 v21, v70, v71
    v_cvt_pk_bf16_f32 v22, v72, v73
    v_cvt_pk_bf16_f32 v23, v74, v75
    ds_write_b128 v6, v[20:23] offset:0
    v_cvt_pk_bf16_f32 v24, v76, v77
    v_cvt_pk_bf16_f32 v25, v78, v79
    v_cvt_pk_bf16_f32 v26, v80, v81
    v_cvt_pk_bf16_f32 v27, v82, v83
    ds_write_b128 v6, v[24:27] offset:4096
    v_lshlrev_b32 v68, 16, v28
    v_and_b32 v69, 0xffff0000, v28
    v_lshlrev_b32 v70, 16, v29
    v_and_b32 v71, 0xffff0000, v29
    v_lshlrev_b32 v72, 16, v30
    v_and_b32 v73, 0xffff0000, v30
    v_lshlrev_b32 v74, 16, v31
    v_and_b32 v75, 0xffff0000, v31
    v_lshlrev_b32 v76, 16, v32
    v_and_b32 v77, 0xffff0000, v32
    v_lshlrev_b32 v78, 16, v33
    v_and_b32 v79, 0xffff0000, v33
    v_lshlrev_b32 v80, 16, v34
    v_and_b32 v81, 0xffff0000, v34
    v_lshlrev_b32 v82, 16, v35
    v_and_b32 v83, 0xffff0000, v35
    v_pk_fma_f32 v[68:69], v[68:69], v[64:65], v[66:67]
    v_pk_fma_f32 v[70:71], v[70:71], v[64:65], v[66:67]
    v_pk_fma_f32 v[72:73], v[72:73], v[64:65], v[66:67]
    v_pk_fma_f32 v[74:75], v[74:75], v[64:65], v[66:67]
    v_pk_fma_f32 v[76:77], v[76:77], v[64:65], v[66:67]
    v_pk_fma_f32 v[78:79], v[78:79], v[64:65], v[66:67]
    v_pk_fma_f32 v[80:81], v[80:81], v[64:65], v[66:67]
    v_pk_fma_f32 v[82:83], v[82:83], v[64:65], v[66:67]
    v_cvt_pk_bf16_f32 v28, v68, v69
    v_cvt_pk_bf16_f32 v29, v70, v71
    v_cvt_pk_bf16_f32 v30, v72, v73
    v_cvt_pk_bf16_f32 v31, v74, v75
    ds_write_b128 v6, v[28:31] offset:8192
    v_cvt_pk_bf16_f32 v32, v76, v77
    v_cvt_pk_bf16_f32 v33, v78, v79
    v_cvt_pk_bf16_f32 v34, v80, v81
    v_cvt_pk_bf16_f32 v35, v82, v83
    ds_write_b128 v6, v[32:35] offset:12288
    v_lshlrev_b32 v68, 16, v36
    v_and_b32 v69, 0xffff0000, v36
    v_lshlrev_b32 v70, 16, v37
    v_and_b32 v71, 0xffff0000, v37
    v_lshlrev_b32 v72, 16, v38
    v_and_b32 v73, 0xffff0000, v38
    v_lshlrev_b32 v74, 16, v39
    v_and_b32 v75, 0xffff0000, v39
    v_lshlrev_b32 v76, 16, v40
    v_and_b32 v77, 0xffff0000, v40
    v_lshlrev_b32 v78, 16, v41
    v_and_b32 v79, 0xffff0000, v41
    v_lshlrev_b32 v80, 16, v42
    v_and_b32 v81, 0xffff0000, v42
    v_lshlrev_b32 v82, 16, v43
    v_and_b32 v83, 0xffff0000, v43
    v_pk_fma_f32 v[68:69], v[68:69], v[64:65], v[66:67]
    v_pk_fma_f32 v[70:71], v[70:71], v[64:65], v[66:67]
    v_pk_fma_f32 v[72:73], v[72:73], v[64:65], v[66:67]
    v_pk_fma_f32 v[74:75], v[74:75], v[64:65], v[66:67]
    v_pk_fma_f32 v[76:77], v[76:77], v[64:65], v[66:67]
    v_pk_fma_f32 v[78:79], v[78:79], v[64:65], v[66:67]
    v_pk_fma_f32 v[80:81], v[80:81], v[64:65], v[66:67]
    v_pk_fma_f32 v[82:83], v[82:83], v[64:65], v[66:67]
    v_cvt_pk_bf16_f32 v36, v68, v69
    v_cvt_pk_bf16_f32 v37, v70, v71
    v_cvt_pk_bf16_f32 v38, v72, v73
    v_cvt_pk_bf16_f32 v39, v74, v75
    ds_write_b128 v6, v[36:39] offset:16384
    v_cvt_pk_bf16_f32 v40, v76, v77
    v_cvt_pk_bf16_f32 v41, v78, v79
    v_cvt_pk_bf16_f32 v42, v80, v81
    v_cvt_pk_bf16_f32 v43, v82, v83
    ds_write_b128 v6, v[40:43] offset:20480
    v_lshlrev_b32 v68, 16, v44
    v_and_b32 v69, 0xffff0000, v44
    v_lshlrev_b32 v70, 16, v45
    v_and_b32 v71, 0xffff0000, v45
    v_lshlrev_b32 v72, 16, v46
    v_and_b32 v73, 0xffff0000, v46
    v_lshlrev_b32 v74, 16, v47
    v_and_b32 v75, 0xffff0000, v47
    v_lshlrev_b32 v76, 16, v48
    v_and_b32 v77, 0xffff0000, v48
    v_lshlrev_b32 v78, 16, v49
    v_and_b32 v79, 0xffff0000, v49
    v_lshlrev_b32 v80, 16, v50
    v_and_b32 v81, 0xffff0000, v50
    v_lshlrev_b32 v82, 16, v51
    v_and_b32 v83, 0xffff0000, v51
    v_pk_fma_f32 v[68:69], v[68:69], v[64:65], v[66:67]
    v_pk_fma_f32 v[70:71], v[70:71], v[64:65], v[66:67]
    v_pk_fma_f32 v[72:73], v[72:73], v[64:65], v[66:67]
    v_pk_fma_f32 v[74:75], v[74:75], v[64:65], v[66:67]
    v_pk_fma_f32 v[76:77], v[76:77], v[64:65], v[66:67]
    v_pk_fma_f32 v[78:79], v[78:79], v[64:65], v[66:67]
    v_pk_fma_f32 v[80:81], v[80:81], v[64:65], v[66:67]
    v_pk_fma_f32 v[82:83], v[82:83], v[64:65], v[66:67]
    v_cvt_pk_bf16_f32 v44, v68, v69
    v_cvt_pk_bf16_f32 v45, v70, v71
    v_cvt_pk_bf16_f32 v46, v72, v73
    v_cvt_pk_bf16_f32 v47, v74, v75
    ds_write_b128 v6, v[44:47] offset:24576
    v_cvt_pk_bf16_f32 v48, v76, v77
    v_cvt_pk_bf16_f32 v49, v78, v79
    v_cvt_pk_bf16_f32 v50, v80, v81
    v_cvt_pk_bf16_f32 v51, v82, v83
    ds_write_b128 v6, v[48:51] offset:28672
    s_waitcnt vmcnt(0) lgkmcnt(0)
    s_barrier
    s_add_u32 s54, s52, 2
    s_and_b32 s54, s54, 7
    s_mul_i32 s55, s54, 196608
    s_add_u32 m0, s53, 49152
    s_add_u32 s50, s56, s55
    buffer_load_dwordx4 v7, s[16:19], s50 offen lds
    s_add_u32 m0, s53, 50176
    s_add_u32 s50, s57, s55
    buffer_load_dwordx4 v7, s[16:19], s50 offen lds
    s_add_u32 m0, s53, 51200
    s_add_u32 s50, s58, s55
    buffer_load_dwordx4 v7, s[16:19], s50 offen lds
    s_add_u32 m0, s53, 52224
    s_add_u32 s50, s59, s55
    buffer_load_dwordx4 v7, s[16:19], s50 offen lds
    s_add_u32 m0, s53, 53248
    s_add_u32 s50, s60, s55
    buffer_load_dwordx4 v7, s[16:19], s50 offen lds
    s_add_u32 m0, s53, 54272
    s_add_u32 s50, s61, s55
    buffer_load_dwordx4 v7, s[16:19], s50 offen lds
    s_add_u32 s54, s52, 3
    s_and_b32 s54, s54, 7
    s_mul_i32 s55, s54, 196608
    s_add_u32 m0, s53, 73728
    s_add_u32 s50, s56, s55
    buffer_load_dwordx4 v7, s[16:19], s50 offen lds
    s_add_u32 m0, s53, 74752
    s_add_u32 s50, s57, s55
    buffer_load_dwordx4 v7, s[16:19], s50 offen lds
    s_add_u32 m0, s53, 75776
    s_add_u32 s50, s58, s55
    buffer_load_dwordx4 v7, s[16:19], s50 offen lds
    s_add_u32 m0, s53, 76800
    s_add_u32 s50, s59, s55
    buffer_load_dwordx4 v7, s[16:19], s50 offen lds
    s_add_u32 m0, s53, 77824
    s_add_u32 s50, s60, s55
    buffer_load_dwordx4 v7, s[16:19], s50 offen lds
    s_add_u32 m0, s53, 78848
    s_add_u32 s50, s61, s55
    buffer_load_dwordx4 v7, s[16:19], s50 offen lds
    s_barrier
    s_add_u32 s54, s52, 4
    s_and_b32 s54, s54, 7
    s_mul_i32 s55, s54, 196608
    s_add_u32 m0, s53, 0
    s_add_u32 s50, s56, s55
    buffer_load_dwordx4 v7, s[16:19], s50 offen lds
    s_add_u32 m0, s53, 1024
    s_add_u32 s50, s57, s55
    buffer_load_dwordx4 v7, s[16:19], s50 offen lds
    s_add_u32 m0, s53, 2048
    s_add_u32 s50, s58, s55
    buffer_load_dwordx4 v7, s[16:19], s50 offen lds
    s_add_u32 m0, s53, 3072
    s_add_u32 s50, s59, s55
    buffer_load_dwordx4 v7, s[16:19], s50 offen lds
    s_add_u32 m0, s53, 4096
    s_add_u32 s50, s60, s55
    buffer_load_dwordx4 v7, s[16:19], s50 offen lds
    s_add_u32 m0, s53, 5120
    s_add_u32 s50, s61, s55
    buffer_load_dwordx4 v7, s[16:19], s50 offen lds
    s_waitcnt vmcnt(12)
    s_barrier
    s_add_u32 s54, s52, 5
    s_and_b32 s54, s54, 7
    s_mul_i32 s55, s54, 196608
    s_add_u32 m0, s53, 24576
    s_add_u32 s50, s56, s55
    buffer_load_dwordx4 v7, s[16:19], s50 offen lds
    s_add_u32 m0, s53, 25600
    s_add_u32 s50, s57, s55
    buffer_load_dwordx4 v7, s[16:19], s50 offen lds
    s_add_u32 m0, s53, 26624
    s_add_u32 s50, s58, s55
    buffer_load_dwordx4 v7, s[16:19], s50 offen lds
    s_add_u32 m0, s53, 27648
    s_add_u32 s50, s59, s55
    buffer_load_dwordx4 v7, s[16:19], s50 offen lds
    s_add_u32 m0, s53, 28672
    s_add_u32 s50, s60, s55
    buffer_load_dwordx4 v7, s[16:19], s50 offen lds
    s_add_u32 m0, s53, 29696
    s_add_u32 s50, s61, s55
    buffer_load_dwordx4 v7, s[16:19], s50 offen lds
    s_waitcnt vmcnt(12)
    s_barrier
    s_add_u32 s54, s52, 6
    s_and_b32 s54, s54, 7
    s_mul_i32 s55, s54, 196608
    s_add_u32 m0, s53, 49152
    s_add_u32 s50, s56, s55
    buffer_load_dwordx4 v7, s[16:19], s50 offen lds
    s_add_u32 m0, s53, 50176
    s_add_u32 s50, s57, s55
    buffer_load_dwordx4 v7, s[16:19], s50 offen lds
    s_add_u32 m0, s53, 51200
    s_add_u32 s50, s58, s55
    buffer_load_dwordx4 v7, s[16:19], s50 offen lds
    s_add_u32 m0, s53, 52224
    s_add_u32 s50, s59, s55
    buffer_load_dwordx4 v7, s[16:19], s50 offen lds
    s_add_u32 m0, s53, 53248
    s_add_u32 s50, s60, s55
    buffer_load_dwordx4 v7, s[16:19], s50 offen lds
    s_add_u32 m0, s53, 54272
    s_add_u32 s50, s61, s55
    buffer_load_dwordx4 v7, s[16:19], s50 offen lds
    s_waitcnt vmcnt(12)
    s_barrier
    s_add_u32 s54, s52, 7
    s_and_b32 s54, s54, 7
    s_mul_i32 s55, s54, 196608
    s_add_u32 m0, s53, 73728
    s_add_u32 s50, s56, s55
    buffer_load_dwordx4 v7, s[16:19], s50 offen lds
    s_add_u32 m0, s53, 74752
    s_add_u32 s50, s57, s55
    buffer_load_dwordx4 v7, s[16:19], s50 offen lds
    s_add_u32 m0, s53, 75776
    s_add_u32 s50, s58, s55
    buffer_load_dwordx4 v7, s[16:19], s50 offen lds
    s_add_u32 m0, s53, 76800
    s_add_u32 s50, s59, s55
    buffer_load_dwordx4 v7, s[16:19], s50 offen lds
    s_add_u32 m0, s53, 77824
    s_add_u32 s50, s60, s55
    buffer_load_dwordx4 v7, s[16:19], s50 offen lds
    s_add_u32 m0, s53, 78848
    s_add_u32 s50, s61, s55
    buffer_load_dwordx4 v7, s[16:19], s50 offen lds
    s_waitcnt vmcnt(12)
    s_barrier
    s_waitcnt vmcnt(6)
    s_barrier
    s_waitcnt vmcnt(0)
    s_barrier
L_sequential_preLN__softmax_full_mha__swiglu_ffn__prompt_p1_done_5:
    s_and_b32 s7, s2, 1
    s_lshl_b32 s7, s7, 2
    s_lshr_b32 s45, s2, 6
    s_add_u32 s7, s7, s45
    s_lshl_b32 s7, s7, 5
    s_bfe_u32 s45, s2, 0x20001
    s_lshl_b32 s45, s45, 3
    s_add_u32 s7, s7, s45
    s_bfe_u32 s45, s2, 0x30003
    s_add_u32 s7, s7, s45
    s_lshl_b32 s7, s7, 2
    s_add_u32 s7, s7, 22937600
    v_mov_b32 v16, 1
    v_mov_b32 v17, 0
    s_waitcnt vmcnt(0)
    s_barrier
    s_cmp_lg_u32 s3, 1
    s_cbranch_scc1 L_sequential_preLN__softmax_full_mha__swiglu_ffn__prompt_nopub_14
    s_mov_b64 exec, 1
    buffer_store_dword v16, v17, s[8:11], s7 offen sc1
    s_mov_b64 exec, -1
L_sequential_preLN__softmax_full_mha__swiglu_ffn__prompt_nopub_14:
    s_and_b32 s48, s2, 7
    s_lshl_b32 s48, s48, 2
    s_bfe_u32 s50, s2, 0x20003
    s_add_u32 s48, s48, s50
    s_lshr_b32 s49, s2, 5
    s_lshl_b32 s49, s49, 3
    s_add_u32 s49, s49, s3
    s_lshl_b32 s52, s48, 16
    s_add_u32 s53, s52, 2097152
    s_lshl_b32 s55, s3, 10
    s_add_u32 s56, s53, s55
    s_cmp_ge_u32 s3, 4
    s_cbranch_scc1 L_sequential_preLN__softmax_full_mha__swiglu_ffn__prompt_noones_15
    v_and_b32 v122, 11, v0
    v_cmp_eq_u32 vcc, 0, v122
    v_mov_b32 v123, 0x3f803f80
    v_mov_b32 v128, 0
    v_cndmask_b32 v124, v128, v123, vcc
    v_cndmask_b32 v125, v128, v123, vcc
    v_cndmask_b32 v126, v128, v123, vcc
    v_cndmask_b32 v127, v128, v123, vcc
    v_lshlrev_b32 v122, 4, v0
    v_add_u32 v122, 131072, v122
    ds_write_b128 v122, v[124:127]
L_sequential_preLN__softmax_full_mha__swiglu_ffn__prompt_noones_15:
    v_mov_b32 v3, v2
    v_and_b32 v122, 15, v1
    v_lshlrev_b32 v122, 4, v122
    v_lshrrev_b32 v123, 5, v1
    v_lshlrev_b32 v123, 8, v123
    v_add_u32 v123, v123, v122
    v_add_u32 v123, 65536, v123
    v_add_u32 v122, 131072, v122
    v_and_b32 v128, 16, v1
    v_cmp_eq_u32 vcc, 0, v128
    v_mov_b32 v129, 4096
    v_mov_b32 v130, 0
    v_cndmask_b32 v6, v122, v123, vcc
    v_cndmask_b32 v7, v130, v129, vcc
    v_mov_b32 v80, 0
    v_mov_b32 v81, 0
    v_mov_b32 v82, 0
    v_mov_b32 v83, 0
    v_mov_b32 v84, 0
    v_mov_b32 v85, 0
    v_mov_b32 v86, 0
    v_mov_b32 v87, 0
    v_mov_b32 v88, 0
    v_mov_b32 v89, 0
    v_mov_b32 v90, 0
    v_mov_b32 v91, 0
    v_mov_b32 v92, 0
    v_mov_b32 v93, 0
    v_mov_b32 v94, 0
    v_mov_b32 v95, 0
    s_cmp_lg_u32 s3, 0
    s_cbranch_scc1 L_sequential_preLN__softmax_full_mha__swiglu_ffn__prompt_nopoll_16
    v_and_b32 v17, 31, v1
    v_lshlrev_b32 v17, 2, v17
    s_add_u32 s44, s6, 22937600
    s_mov_b32 s45, 0
L_sequential_preLN__softmax_full_mha__swiglu_ffn__prompt_spin_17:
    s_add_u32 s45, s45, 1
    s_cmp_gt_u32 s45, 1048576
    s_cbranch_scc1 L_sequential_preLN__softmax_full_mha__swiglu_ffn__prompt_spin_out_18
    buffer_load_dword v16, v17, s[8:11], s44 offen sc1
    s_waitcnt vmcnt(0)
    v_cmp_ne_u32 vcc, 1, v16
    s_cbranch_vccnz L_sequential_preLN__softmax_full_mha__swiglu_ffn__prompt_spin_17
L_sequential_preLN__softmax_full_mha__swiglu_ffn__prompt_spin_out_18:
L_sequential_preLN__softmax_full_mha__swiglu_ffn__prompt_nopoll_16:
    s_barrier
    s_lshl_b32 s50, s49, 10
    s_add_u32 s50, s50, s52
    buffer_load_dwordx4 v[20:23], v2, s[8:11], s50 offen sc1
    v_and_b32 v120, 7, v1
    v_lshlrev_b32 v120, 7, v120
    s_lshl_b32 s50, s48, 13
    s_add_u32 s50, s50, s55
    s_add_u32 s50, s50, 23068672
    buffer_load_dword v121, v120, s[8:11], s50 offen sc1
    s_add_u32 m0, s55, 0
    s_add_u32 s51, s56, 0
    buffer_load_dwordx4 v2, s[8:11], s51 offen sc1 lds
    s_add_u32 m0, s55, 65536
    s_add_u32 s51, s56, 2097152
    buffer_load_dwordx4 v2, s[8:11], s51 offen sc1 lds
    s_mov_b32 s57, 0
    s_sub_u32 s58, s3, 0
    s_cmp_ge_u32 s58, 3
    s_cbranch_scc1 L_sequential_preLN__softmax_full_mha__swiglu_ffn__prompt_noside_19
    s_lshl_b32 s64, s58, 13
    s_add_u32 s64, s64, 135168
    s_lshl_b32 s58, s58, 8
    s_add_u32 s58, s58, s2
    s_cmp_ge_u32 s58, 592
    s_cbranch_scc1 L_sequential_preLN__softmax_full_mha__swiglu_ffn__prompt_noside_19
    s_cmp_ge_u32 s58, 240
    s_cbranch_scc1 L_sequential_preLN__softmax_full_mha__swiglu_ffn__prompt_unit_gu_21
    s_cmp_ge_u32 s58, 64
    s_cbranch_scc1 L_sequential_preLN__softmax_full_mha__swiglu_ffn__prompt_unit_wd_20
    s_mov_b32 s57, 1
    s_and_b32 s59, s58, 7
    s_lshr_b32 s60, s58, 3
    s_lshl_b32 s61, s60, 16
    s_lshl_b32 s65, s59, 7
    s_add_u32 s61, s61, s65
    s_mul_i32 s62, s59, 65536
    s_lshl_b32 s65, s60, 12
    s_add_u32 s62, s62, s65
    s_add_u32 s62, s62, 16777216
    s_mov_b32 s63, 32768
    s_branch L_sequential_preLN__softmax_full_mha__swiglu_ffn__prompt_noside_19
L_sequential_preLN__softmax_full_mha__swiglu_ffn__prompt_unit_wd_20:
    s_mov_b32 s57, 2
    s_sub_u32 s58, s58, 64
    s_and_b32 s59, s58, 7
    s_lshr_b32 s60, s58, 3
    s_lshl_b32 s61, s60, 16
    s_lshl_b32 s65, s59, 7
    s_add_u32 s61, s61, s65
    s_mul_i32 s62, s59, 180224
    s_lshl_b32 s65, s60, 12
    s_add_u32 s62, s62, s65
    s_add_u32 s62, s62, 17301504
    s_mov_b32 s63, 90112
    s_branch L_sequential_preLN__softmax_full_mha__swiglu_ffn__prompt_noside_19
L_sequential_preLN__softmax_full_mha__swiglu_ffn__prompt_unit_gu_21:
    s_mov_b32 s57, 3
    s_sub_u32 s58, s58, 240
    s_and_b32 s60, s58, 15
    s_lshr_b32 s59, s58, 4
    s_mul_i32 s61, s60, 88064
    s_lshl_b32 s65, s59, 7
    s_add_u32 s61, s61, s65
    s_mul_i32 s62, s59, 131072
    s_lshl_b32 s65, s60, 11
    s_add_u32 s62, s62, s65
    s_add_u32 s62, s62, 18874368
L_sequential_preLN__softmax_full_mha__swiglu_ffn__prompt_noside_19:
    s_waitcnt vmcnt(2)
    v_dot2_f32_bf16 v131, v20, v20, 0
    v_dot2_f32_bf16 v131, v21, v21, v131
    v_dot2_f32_bf16 v131, v22, v22, v131
    v_dot2_f32_bf16 v131, v23, v23, v131
    s_nop 1
    v_max_f32_dpp v121, v121, v121 quad_perm:[1,0,3,2] row_mask:0xf bank_mask:0xf
    s_nop 1
    v_max_f32_dpp v121, v121, v121 quad_perm:[2,3,0,1] row_mask:0xf bank_mask:0xf
    s_nop 1
    v_max_f32_dpp v121, v121, v121 row_half_mirror row_mask:0xf bank_mask:0xf
    s_lshl_b32 s50, s3, 2
    s_add_u32 s50, s50, 159744
    v_mov_b32 v124, s50
    ds_write_b32 v124, v121
    v_mov_b32 v126, v131
    v_mov_b32 v127, v131
    s_nop 1
    v_permlane32_swap_b32 v126, v127
    v_add_f32 v131, v126, v127
    s_waitcnt vmcnt(0) lgkmcnt(0)
    s_barrier
    v_mov_b32 v124, 159744
    ds_read_b128 v[132:135], v124
    ds_read_b128 v[136:139], v124 offset:16
    ds_read_b128 v[96:99], v3
    ds_read_b128 v[100:103], v3 offset:1024
    ds_read_b128 v[104:107], v6
    ds_read_b128 v[108:111], v6 offset:512
    s_mov_b32 s51, 0x42480000
    s_waitcnt lgkmcnt(4)
    v_max3_f32 v121, v132, v133, v134
    v_max3_f32 v122, v135, v136, v137
    v_max3_f32 v121, v138, v139, v121
    v_max_f32 v121, v122, v121
    v_mul_f32 v131, v131, v121
    v_sqrt_f32 v131, v131
    s_nop 0
    v_mul_f32 v131, 0x3f8147ae, v131
    v_cmp_nge_f32 vcc, s51, v131
    s_nop 4
    s_cbranch_vccz L_sequential_preLN__softmax_full_mha__swiglu_ffn__prompt_fast_22
    v_mov_b32 v131, 0xff800000
    s_mov_b32 s54, 0
L_sequential_preLN__softmax_full_mha__swiglu_ffn__prompt_slow_23:
    s_lshl_b32 s51, s54, 10
    s_add_u32 s51, s51, s53
    buffer_load_dwordx4 v[140:143], v2, s[8:11], s51 offen sc1
    s_waitcnt vmcnt(0)
    v_mfma_f32_32x32x16_bf16 v[40:55], v[140:143], v[20:23], 0
    s_nop 11
    v_max3_f32 v131, v40, v41, v131
    v_max3_f32 v131, v42, v43, v131
    v_max3_f32 v131, v44, v45, v131
    v_max3_f32 v131, v46, v47, v131
    v_max3_f32 v131, v48, v49, v131
    v_max3_f32 v131, v50, v51, v131
    v_max3_f32 v131, v52, v53, v131
    v_max3_f32 v131, v54, v55, v131
    s_add_u32 s54, s54, 1
    s_cmp_lt_u32 s54, 64
    s_cbranch_scc1 L_sequential_preLN__softmax_full_mha__swiglu_ffn__prompt_slow_23
    v_mov_b32 v124, v131
    v_mov_b32 v125, v131
    s_nop 1
    v_permlane32_swap_b32 v124, v125
    v_max_f32 v131, v124, v125
L_sequential_preLN__softmax_full_mha__swiglu_ffn__prompt_fast_22:
    v_sub_f32 v24, 0, v131
    v_sub_f32 v25, 0, v131
    v_sub_f32 v26, 0, v131
    v_sub_f32 v27, 0, v131
    v_sub_f32 v28, 0, v131
    v_sub_f32 v29, 0, v131
    v_sub_f32 v30, 0, v131
    v_sub_f32 v31, 0, v131
    v_sub_f32 v32, 0, v131
    v_sub_f32 v33, 0, v131
    v_sub_f32 v34, 0, v131
    v_sub_f32 v35, 0, v131
    v_sub_f32 v36, 0, v131
    v_sub_f32 v37, 0, v131
    v_sub_f32 v38, 0, v131
    v_sub_f32 v39, 0, v131
    s_nop 0
    s_waitcnt lgkmcnt(3)
    v_mfma_f32_32x32x16_bf16 v[40:55], v[96:99], v[20:23], v[24:39]
    s_nop 11
    v_exp_f32 v40, v40
    v_exp_f32 v41, v41
    v_exp_f32 v42, v42
    v_exp_f32 v43, v43
    s_setprio 3
    v_exp_f32 v44, v44
    v_exp_f32 v45, v45
    v_cvt_pk_bf16_f32 v72, v40, v41
    v_cvt_pk_bf16_f32 v73, v42, v43
    s_waitcnt lgkmcnt(2)
    v_mfma_f32_32x32x16_bf16 v[56:71], v[100:103], v[20:23], v[24:39]
    ds_read_b128 v[96:99], v3 offset:2048
    v_exp_f32 v46, v46
    v_exp_f32 v47, v47
    v_exp_f32 v48, v48
    v_exp_f32 v49, v49
    v_cvt_pk_bf16_f32 v74, v44, v45
    v_cvt_pk_bf16_f32 v75, v46, v47
    v_exp_f32 v50, v50
    v_exp_f32 v51, v51
    s_add_u32 m0, s55, 8192
    s_add_u32 s51, s56, 8192
    buffer_load_dwordx4 v2, s[8:11], s51 offen sc1 lds
    s_add_u32 m0, s55, 73728
    s_add_u32 s51, s56, 2105344
    buffer_load_dwordx4 v2, s[8:11], s51 offen sc1 lds
    s_waitcnt lgkmcnt(1)
    v_mfma_f32_32x32x16_bf16 v[80:95], v[104:107], v[72:75], v[80:95]
    v_exp_f32 v52, v52
    v_exp_f32 v53, v53
    v_cvt_pk_bf16_f32 v76, v48, v49
    v_cvt_pk_bf16_f32 v77, v50, v51
    v_exp_f32 v54, v54
    v_exp_f32 v55, v55
    v_exp_f32 v56, v56
    v_exp_f32 v57, v57
    v_cvt_pk_bf16_f32 v78, v52, v53
    v_cvt_pk_bf16_f32 v79, v54, v55
    ds_read_b128 v[112:115], v6 offset:1024
    ds_read_b128 v[116:119], v6 offset:1536
    v_exp_f32 v58, v58
    v_exp_f32 v59, v59
    v_mfma_f32_32x32x16_bf16 v[80:95], v[108:111], v[76:79], v[80:95]
    v_exp_f32 v60, v60
    v_exp_f32 v61, v61
    v_cvt_pk_bf16_f32 v72, v56, v57
    v_cvt_pk_bf16_f32 v73, v58, v59
    s_waitcnt lgkmcnt(2)
    v_mfma_f32_32x32x16_bf16 v[40:55], v[96:99], v[20:23], v[24:39]
    ds_read_b128 v[100:103], v3 offset:3072
    v_exp_f32 v62, v62
    v_exp_f32 v63, v63
    v_exp_f32 v64, v64
    v_exp_f32 v65, v65
    v_cvt_pk_bf16_f32 v74, v60, v61
    v_cvt_pk_bf16_f32 v75, v62, v63
    v_exp_f32 v66, v66
    v_exp_f32 v67, v67
    s_add_u32 m0, s55, 16384
    s_add_u32 s51, s56, 16384
    buffer_load_dwordx4 v2, s[8:11], s51 offen sc1 lds
    s_add_u32 m0, s55, 81920
    s_add_u32 s51, s56, 2113536
    buffer_load_dwordx4 v2, s[8:11], s51 offen sc1 lds
    s_add_u32 m0, s55, 24576
    s_add_u32 s51, s56, 24576
    buffer_load_dwordx4 v2, s[8:11], s51 offen sc1 lds
    s_add_u32 m0, s55, 90112
    s_add_u32 s51, s56, 2121728
    buffer_load_dwordx4 v2, s[8:11], s51 offen sc1 lds
    s_waitcnt lgkmcnt(1)
    v_mfma_f32_32x32x16_bf16 v[80:95], v[112:115], v[72:75], v[80:95]
    v_exp_f32 v68, v68
    v_exp_f32 v69, v69
    v_cvt_pk_bf16_f32 v76, v64, v65
    v_cvt_pk_bf16_f32 v77, v66, v67
    v_exp_f32 v70, v70
    v_exp_f32 v71, v71
    v_exp_f32 v40, v40
    v_exp_f32 v41, v41
    v_cvt_pk_bf16_f32 v78, v68, v69
    v_cvt_pk_bf16_f32 v79, v70, v71
    ds_read_b128 v[104:107], v6 offset:2048
    ds_read_b128 v[108:111], v6 offset:2560
    v_exp_f32 v42, v42
    v_exp_f32 v43, v43
    v_mfma_f32_32x32x16_bf16 v[80:95], v[116:119], v[76:79], v[80:95]
    s_setprio 2
    v_exp_f32 v44, v44
    v_exp_f32 v45, v45
    v_cvt_pk_bf16_f32 v72, v40, v41
    v_cvt_pk_bf16_f32 v73, v42, v43
    s_waitcnt lgkmcnt(2)
    v_mfma_f32_32x32x16_bf16 v[56:71], v[100:103], v[20:23], v[24:39]
    ds_read_b128 v[96:99], v3 offset:4096
    v_exp_f32 v46, v46
    v_exp_f32 v47, v47
    v_exp_f32 v48, v48
    v_exp_f32 v49, v49
    v_cvt_pk_bf16_f32 v74, v44, v45
    v_cvt_pk_bf16_f32 v75, v46, v47
    v_exp_f32 v50, v50
    v_exp_f32 v51, v51
    s_add_u32 m0, s55, 32768
    s_add_u32 s51, s56, 32768
    buffer_load_dwordx4 v2, s[8:11], s51 offen sc1 lds
    s_add_u32 m0, s55, 98304
    s_add_u32 s51, s56, 2129920
    buffer_load_dwordx4 v2, s[8:11], s51 offen sc1 lds
    s_waitcnt lgkmcnt(1)
    v_mfma_f32_32x32x16_bf16 v[80:95], v[104:107], v[72:75], v[80:95]
    v_exp_f32 v52, v52
    v_exp_f32 v53, v53
    v_cvt_pk_bf16_f32 v76, v48, v49
    v_cvt_pk_bf16_f32 v77, v50, v51
    v_exp_f32 v54, v54
    v_exp_f32 v55, v55
    v_exp_f32 v56, v56
    v_exp_f32 v57, v57
    v_cvt_pk_bf16_f32 v78, v52, v53
    v_cvt_pk_bf16_f32 v79, v54, v55
    ds_read_b128 v[112:115], v6 offset:3072
    ds_read_b128 v[116:119], v6 offset:3584
    v_exp_f32 v58, v58
    v_exp_f32 v59, v59
    v_mfma_f32_32x32x16_bf16 v[80:95], v[108:111], v[76:79], v[80:95]
    s_setprio 1
    v_exp_f32 v60, v60
    v_exp_f32 v61, v61
    v_cvt_pk_bf16_f32 v72, v56, v57
    v_cvt_pk_bf16_f32 v73, v58, v59
    s_waitcnt lgkmcnt(2)
    v_mfma_f32_32x32x16_bf16 v[40:55], v[96:99], v[20:23], v[24:39]
    ds_read_b128 v[100:103], v3 offset:5120
    v_exp_f32 v62, v62
    v_exp_f32 v63, v63
    v_exp_f32 v64, v64
    v_exp_f32 v65, v65
    v_cvt_pk_bf16_f32 v74, v60, v61
    v_cvt_pk_bf16_f32 v75, v62, v63
    v_exp_f32 v66, v66
    v_exp_f32 v67, v67
    s_add_u32 m0, s55, 40960
    s_add_u32 s51, s56, 40960
    buffer_load_dwordx4 v2, s[8:11], s51 offen sc1 lds
    s_add_u32 m0, s55, 106496
    s_add_u32 s51, s56, 2138112
    buffer_load_dwordx4 v2, s[8:11], s51 offen sc1 lds
    s_add_u32 m0, s55, 49152
    s_add_u32 s51, s56, 49152
    buffer_load_dwordx4 v2, s[8:11], s51 offen sc1 lds
    s_add_u32 m0, s55, 114688
    s_add_u32 s51, s56, 2146304
    buffer_load_dwordx4 v2, s[8:11], s51 offen sc1 lds
    s_waitcnt lgkmcnt(1)
    v_mfma_f32_32x32x16_bf16 v[80:95], v[112:115], v[72:75], v[80:95]
    v_exp_f32 v68, v68
    v_exp_f32 v69, v69
    v_cvt_pk_bf16_f32 v76, v64, v65
    v_cvt_pk_bf16_f32 v77, v66, v67
    v_exp_f32 v70, v70
    v_exp_f32 v71, v71
    v_exp_f32 v40, v40
    v_exp_f32 v41, v41
    v_cvt_pk_bf16_f32 v78, v68, v69
    v_cvt_pk_bf16_f32 v79, v70, v71
    v_add_u32 v6, v6, v7
    ds_read_b128 v[104:107], v6 offset:0
    ds_read_b128 v[108:111], v6 offset:512
    v_exp_f32 v42, v42
    v_exp_f32 v43, v43
    v_mfma_f32_32x32x16_bf16 v[80:95], v[116:119], v[76:79], v[80:95]
    s_setprio 0
    v_exp_f32 v44, v44
    v_exp_f32 v45, v45
    v_cvt_pk_bf16_f32 v72, v40, v41
    v_cvt_pk_bf16_f32 v73, v42, v43
    s_waitcnt lgkmcnt(2)
    v_mfma_f32_32x32x16_bf16 v[56:71], v[100:103], v[20:23], v[24:39]
    ds_read_b128 v[96:99], v3 offset:6144
    v_exp_f32 v46, v46
    v_exp_f32 v47, v47
    v_exp_f32 v48, v48
    v_exp_f32 v49, v49
    v_cvt_pk_bf16_f32 v74, v44, v45
    v_cvt_pk_bf16_f32 v75, v46, v47
    v_exp_f32 v50, v50
    v_exp_f32 v51, v51
    s_add_u32 m0, s55, 57344
    s_add_u32 s51, s56, 57344
    buffer_load_dwordx4 v2, s[8:11], s51 offen sc1 lds
    s_add_u32 m0, s55, 122880
    s_add_u32 s51, s56, 2154496
    buffer_load_dwordx4 v2, s[8:11], s51 offen sc1 lds
    s_waitcnt lgkmcnt(1)
    v_mfma_f32_32x32x16_bf16 v[80:95], v[104:107], v[72:75], v[80:95]
    v_exp_f32 v52, v52
    v_exp_f32 v53, v53
    v_cvt_pk_bf16_f32 v76, v48, v49
    v_cvt_pk_bf16_f32 v77, v50, v51
    v_exp_f32 v54, v54
    v_exp_f32 v55, v55
    v_exp_f32 v56, v56
    v_exp_f32 v57, v57
    v_cvt_pk_bf16_f32 v78, v52, v53
    v_cvt_pk_bf16_f32 v79, v54, v55
    ds_read_b128 v[112:115], v6 offset:1024
    ds_read_b128 v[116:119], v6 offset:1536
    v_exp_f32 v58, v58
    v_exp_f32 v59, v59
    v_mfma_f32_32x32x16_bf16 v[80:95], v[108:111], v[76:79], v[80:95]
    v_exp_f32 v60, v60
    v_exp_f32 v61, v61
    v_cvt_pk_bf16_f32 v72, v56, v57
    v_cvt_pk_bf16_f32 v73, v58, v59
    s_waitcnt lgkmcnt(2)
    v_mfma_f32_32x32x16_bf16 v[40:55], v[96:99], v[20:23], v[24:39]
    ds_read_b128 v[100:103], v3 offset:7168
    v_exp_f32 v62, v62
    v_exp_f32 v63, v63
    v_exp_f32 v64, v64
    v_exp_f32 v65, v65
    v_cvt_pk_bf16_f32 v74, v60, v61
    v_cvt_pk_bf16_f32 v75, v62, v63
    v_exp_f32 v66, v66
    v_exp_f32 v67, v67
    s_waitcnt lgkmcnt(1)
    v_mfma_f32_32x32x16_bf16 v[80:95], v[112:115], v[72:75], v[80:95]
    v_exp_f32 v68, v68
    v_exp_f32 v69, v69
    v_cvt_pk_bf16_f32 v76, v64, v65
    v_cvt_pk_bf16_f32 v77, v66, v67
    v_exp_f32 v70, v70
    v_exp_f32 v71, v71
    v_exp_f32 v40, v40
    v_exp_f32 v41, v41
    v_cvt_pk_bf16_f32 v78, v68, v69
    v_cvt_pk_bf16_f32 v79, v70, v71
    ds_read_b128 v[104:107], v6 offset:2048
    ds_read_b128 v[108:111], v6 offset:2560
    v_exp_f32 v42, v42
    v_exp_f32 v43, v43
    v_mfma_f32_32x32x16_bf16 v[80:95], v[116:119], v[76:79], v[80:95]
    s_waitcnt vmcnt(0)
    s_barrier
    s_cmp_eq_u32 s57, 0
    s_cbranch_scc1 L_sequential_preLN__softmax_full_mha__swiglu_ffn__prompt_sidei_done_24
    v_lshrrev_b32 v120, 4, v1
    v_and_b32 v120, 1, v120
    v_lshlrev_b32 v120, 2, v120
    v_and_b32 v121, 7, v1
    v_xor_b32 v120, v120, v121
    v_lshlrev_b32 v120, 4, v120
    v_lshrrev_b32 v121, 3, v1
    s_cmp_eq_u32 s57, 3
    s_cbranch_scc1 L_sequential_preLN__softmax_full_mha__swiglu_ffn__prompt_sidei_gu_25
    v_lshlrev_b32 v121, 10, v121
    v_add_u32 v120, v120, v121
    s_cmp_eq_u32 s57, 2
    s_cbranch_scc1 L_sequential_preLN__softmax_full_mha__swiglu_ffn__prompt_sidei_wd_26
    s_add_u32 m0, s64, 0
    s_add_u32 s65, s61, 0
    buffer_load_dwordx4 v120, s[20:23], s65 offen lds
    s_add_u32 m0, s64, 1024
    s_add_u32 s65, s61, 8192
    buffer_load_dwordx4 v120, s[20:23], s65 offen lds
    s_add_u32 m0, s64, 2048
    s_add_u32 s65, s61, 16384
    buffer_load_dwordx4 v120, s[20:23], s65 offen lds
    s_add_u32 m0, s64, 3072
    s_add_u32 s65, s61, 24576
    buffer_load_dwordx4 v120, s[20:23], s65 offen lds
    s_add_u32 m0, s64, 4096
    s_add_u32 s65, s61, 32768
    buffer_load_dwordx4 v120, s[20:23], s65 offen lds
    s_add_u32 m0, s64, 5120
    s_add_u32 s65, s61, 40960
    buffer_load_dwordx4 v120, s[20:23], s65 offen lds
    s_add_u32 m0, s64, 6144
    s_add_u32 s65, s61, 49152
    buffer_load_dwordx4 v120, s[20:23], s65 offen lds
    s_add_u32 m0, s64, 7168
    s_add_u32 s65, s61, 57344
    buffer_load_dwordx4 v120, s[20:23], s65 offen lds
    s_branch L_sequential_preLN__softmax_full_mha__swiglu_ffn__prompt_sidei_done_24
L_sequential_preLN__softmax_full_mha__swiglu_ffn__prompt_sidei_wd_26:
    s_add_u32 m0, s64, 0
    s_add_u32 s65, s61, 0
    buffer_load_dwordx4 v120, s[32:35], s65 offen lds
    s_add_u32 m0, s64, 1024
    s_add_u32 s65, s61, 8192
    buffer_load_dwordx4 v120, s[32:35], s65 offen lds
    s_add_u32 m0, s64, 2048
    s_add_u32 s65, s61, 16384
    buffer_load_dwordx4 v120, s[32:35], s65 offen lds
    s_add_u32 m0, s64, 3072
    s_add_u32 s65, s61, 24576
    buffer_load_dwordx4 v120, s[32:35], s65 offen lds
    s_add_u32 m0, s64, 4096
    s_add_u32 s65, s61, 32768
    buffer_load_dwordx4 v120, s[32:35], s65 offen lds
    s_add_u32 m0, s64, 5120
    s_add_u32 s65, s61, 40960
    buffer_load_dwordx4 v120, s[32:35], s65 offen lds
    s_add_u32 m0, s64, 6144
    s_add_u32 s65, s61, 49152
    buffer_load_dwordx4 v120, s[32:35], s65 offen lds
    s_add_u32 m0, s64, 7168
    s_add_u32 s65, s61, 57344
    buffer_load_dwordx4 v120, s[32:35], s65 offen lds
    s_branch L_sequential_preLN__softmax_full_mha__swiglu_ffn__prompt_sidei_done_24
L_sequential_preLN__softmax_full_mha__swiglu_ffn__prompt_sidei_gu_25:
    v_mul_u32_u24 v121, 2752, v121
    v_add_u32 v120, v120, v121
    s_add_u32 m0, s64, 0
    s_add_u32 s65, s61, 0
    buffer_load_dwordx4 v120, s[24:27], s65 offen lds
    s_add_u32 m0, s64, 1024
    s_add_u32 s65, s61, 22016
    buffer_load_dwordx4 v120, s[24:27], s65 offen lds
    s_add_u32 m0, s64, 2048
    s_add_u32 s65, s61, 44032
    buffer_load_dwordx4 v120, s[24:27], s65 offen lds
    s_add_u32 m0, s64, 3072
    s_add_u32 s65, s61, 66048
    buffer_load_dwordx4 v120, s[24:27], s65 offen lds
    s_add_u32 m0, s64, 4096
    s_add_u32 s65, s61, 0
    buffer_load_dwordx4 v120, s[28:31], s65 offen lds
    s_add_u32 m0, s64, 5120
    s_add_u32 s65, s61, 22016
    buffer_load_dwordx4 v120, s[28:31], s65 offen lds
    s_add_u32 m0, s64, 6144
    s_add_u32 s65, s61, 44032
    buffer_load_dwordx4 v120, s[28:31], s65 offen lds
    s_add_u32 m0, s64, 7168
    s_add_u32 s65, s61, 66048
    buffer_load_dwordx4 v120, s[28:31], s65 offen lds
L_sequential_preLN__softmax_full_mha__swiglu_ffn__prompt_sidei_done_24:
    s_setprio 3
    v_exp_f32 v44, v44
    v_exp_f32 v45, v45
    v_cvt_pk_bf16_f32 v72, v40, v41
    v_cvt_pk_bf16_f32 v73, v42, v43
    s_waitcnt lgkmcnt(2)
    v_mfma_f32_32x32x16_bf16 v[56:71], v[100:103], v[20:23], v[24:39]
    ds_read_b128 v[96:99], v3 offset:8192
    v_exp_f32 v46, v46
    v_exp_f32 v47, v47
    v_exp_f32 v48, v48
    v_exp_f32 v49, v49
    v_cvt_pk_bf16_f32 v74, v44, v45
    v_cvt_pk_bf16_f32 v75, v46, v47
    v_exp_f32 v50, v50
    v_exp_f32 v51, v51
    s_waitcnt lgkmcnt(1)
    v_mfma_f32_32x32x16_bf16 v[80:95], v[104:107], v[72:75], v[80:95]
    v_exp_f32 v52, v52
    v_exp_f32 v53, v53
    v_cvt_pk_bf16_f32 v76, v48, v49
    v_cvt_pk_bf16_f32 v77, v50, v51
    v_exp_f32 v54, v54
    v_exp_f32 v55, v55
    v_exp_f32 v56, v56
    v_exp_f32 v57, v57
    v_cvt_pk_bf16_f32 v78, v52, v53
    v_cvt_pk_bf16_f32 v79, v54, v55
    ds_read_b128 v[112:115], v6 offset:3072
    ds_read_b128 v[116:119], v6 offset:3584
    v_exp_f32 v58, v58
    v_exp_f32 v59, v59
    v_mfma_f32_32x32x16_bf16 v[80:95], v[108:111], v[76:79], v[80:95]
    v_exp_f32 v60, v60
    v_exp_f32 v61, v61
    v_cvt_pk_bf16_f32 v72, v56, v57
    v_cvt_pk_bf16_f32 v73, v58, v59
    s_waitcnt lgkmcnt(2)
    v_mfma_f32_32x32x16_bf16 v[40:55], v[96:99], v[20:23], v[24:39]
    ds_read_b128 v[100:103], v3 offset:9216
    v_exp_f32 v62, v62
    v_exp_f32 v63, v63
    v_exp_f32 v64, v64
    v_exp_f32 v65, v65
    v_cvt_pk_bf16_f32 v74, v60, v61
    v_cvt_pk_bf16_f32 v75, v62, v63
    v_exp_f32 v66, v66
    v_exp_f32 v67, v67
    s_waitcnt lgkmcnt(1)
    v_mfma_f32_32x32x16_bf16 v[80:95], v[112:115], v[72:75], v[80:95]
    v_exp_f32 v68, v68
    v_exp_f32 v69, v69
    v_cvt_pk_bf16_f32 v76, v64, v65
    v_cvt_pk_bf16_f32 v77, v66, v67
    v_exp_f32 v70, v70
    v_exp_f32 v71, v71
    v_exp_f32 v40, v40
    v_exp_f32 v41, v41
    v_cvt_pk_bf16_f32 v78, v68, v69
    v_cvt_pk_bf16_f32 v79, v70, v71
    v_add_u32 v6, v6, v7
    ds_read_b128 v[104:107], v6 offset:0
    ds_read_b128 v[108:111], v6 offset:512
    v_exp_f32 v42, v42
    v_exp_f32 v43, v43
    v_mfma_f32_32x32x16_bf16 v[80:95], v[116:119], v[76:79], v[80:95]
    v_exp_f32 v44, v44
    v_exp_f32 v45, v45
    v_cvt_pk_bf16_f32 v72, v40, v41
    v_cvt_pk_bf16_f32 v73, v42, v43
    s_waitcnt lgkmcnt(2)
    v_mfma_f32_32x32x16_bf16 v[56:71], v[100:103], v[20:23], v[24:39]
    ds_read_b128 v[96:99], v3 offset:10240
    v_exp_f32 v46, v46
    v_exp_f32 v47, v47
    v_exp_f32 v48, v48
    v_exp_f32 v49, v49
    v_cvt_pk_bf16_f32 v74, v44, v45
    v_cvt_pk_bf16_f32 v75, v46, v47
    v_exp_f32 v50, v50
    v_exp_f32 v51, v51
    s_waitcnt lgkmcnt(1)
    v_mfma_f32_32x32x16_bf16 v[80:95], v[104:107], v[72:75], v[80:95]
    v_exp_f32 v52, v52
    v_exp_f32 v53, v53
    v_cvt_pk_bf16_f32 v76, v48, v49
    v_cvt_pk_bf16_f32 v77, v50, v51
    v_exp_f32 v54, v54
    v_exp_f32 v55, v55
    v_exp_f32 v56, v56
    v_exp_f32 v57, v57
    v_cvt_pk_bf16_f32 v78, v52, v53
    v_cvt_pk_bf16_f32 v79, v54, v55
    ds_read_b128 v[112:115], v6 offset:1024
    ds_read_b128 v[116:119], v6 offset:1536
    v_exp_f32 v58, v58
    v_exp_f32 v59, v59
    v_mfma_f32_32x32x16_bf16 v[80:95], v[108:111], v[76:79], v[80:95]
    v_exp_f32 v60, v60
    v_exp_f32 v61, v61
    v_cvt_pk_bf16_f32 v72, v56, v57
    v_cvt_pk_bf16_f32 v73, v58, v59
    s_waitcnt lgkmcnt(2)
    v_mfma_f32_32x32x16_bf16 v[40:55], v[96:99], v[20:23], v[24:39]
    ds_read_b128 v[100:103], v3 offset:11264
    v_exp_f32 v62, v62
    v_exp_f32 v63, v63
    v_exp_f32 v64, v64
    v_exp_f32 v65, v65
    v_cvt_pk_bf16_f32 v74, v60, v61
    v_cvt_pk_bf16_f32 v75, v62, v63
    v_exp_f32 v66, v66
    v_exp_f32 v67, v67
    s_waitcnt lgkmcnt(1)
    v_mfma_f32_32x32x16_bf16 v[80:95], v[112:115], v[72:75], v[80:95]
    v_exp_f32 v68, v68
    v_exp_f32 v69, v69
    v_cvt_pk_bf16_f32 v76, v64, v65
    v_cvt_pk_bf16_f32 v77, v66, v67
    v_exp_f32 v70, v70
    v_exp_f32 v71, v71
    v_exp_f32 v40, v40
    v_exp_f32 v41, v41
    v_cvt_pk_bf16_f32 v78, v68, v69
    v_cvt_pk_bf16_f32 v79, v70, v71
    ds_read_b128 v[104:107], v6 offset:2048
    ds_read_b128 v[108:111], v6 offset:2560
    v_exp_f32 v42, v42
    v_exp_f32 v43, v43
    v_mfma_f32_32x32x16_bf16 v[80:95], v[116:119], v[76:79], v[80:95]
    v_exp_f32 v44, v44
    v_exp_f32 v45, v45
    v_cvt_pk_bf16_f32 v72, v40, v41
    v_cvt_pk_bf16_f32 v73, v42, v43
    s_waitcnt lgkmcnt(2)
    v_mfma_f32_32x32x16_bf16 v[56:71], v[100:103], v[20:23], v[24:39]
    ds_read_b128 v[96:99], v3 offset:12288
    v_exp_f32 v46, v46
    v_exp_f32 v47, v47
    v_exp_f32 v48, v48
    v_exp_f32 v49, v49
    v_cvt_pk_bf16_f32 v74, v44, v45
    v_cvt_pk_bf16_f32 v75, v46, v47
    v_exp_f32 v50, v50
    v_exp_f32 v51, v51
    s_waitcnt lgkmcnt(1)
    v_mfma_f32_32x32x16_bf16 v[80:95], v[104:107], v[72:75], v[80:95]
    v_exp_f32 v52, v52
    v_exp_f32 v53, v53
    v_cvt_pk_bf16_f32 v76, v48, v49
    v_cvt_pk_bf16_f32 v77, v50, v51
    v_exp_f32 v54, v54
    v_exp_f32 v55, v55
    v_exp_f32 v56, v56
    v_exp_f32 v57, v57
    v_cvt_pk_bf16_f32 v78, v52, v53
    v_cvt_pk_bf16_f32 v79, v54, v55
    ds_read_b128 v[112:115], v6 offset:3072
    ds_read_b128 v[116:119], v6 offset:3584
    v_exp_f32 v58, v58
    v_exp_f32 v59, v59
    v_mfma_f32_32x32x16_bf16 v[80:95], v[108:111], v[76:79], v[80:95]
    v_exp_f32 v60, v60
    v_exp_f32 v61, v61
    v_cvt_pk_bf16_f32 v72, v56, v57
    v_cvt_pk_bf16_f32 v73, v58, v59
    s_waitcnt lgkmcnt(2)
    v_mfma_f32_32x32x16_bf16 v[40:55], v[96:99], v[20:23], v[24:39]
    ds_read_b128 v[100:103], v3 offset:13312
    v_exp_f32 v62, v62
    v_exp_f32 v63, v63
    v_exp_f32 v64, v64
    v_exp_f32 v65, v65
    v_cvt_pk_bf16_f32 v74, v60, v61
    v_cvt_pk_bf16_f32 v75, v62, v63
    v_exp_f32 v66, v66
    v_exp_f32 v67, v67
    s_waitcnt lgkmcnt(1)
    v_mfma_f32_32x32x16_bf16 v[80:95], v[112:115], v[72:75], v[80:95]
    v_exp_f32 v68, v68
    v_exp_f32 v69, v69
    v_cvt_pk_bf16_f32 v76, v64, v65
    v_cvt_pk_bf16_f32 v77, v66, v67
    v_exp_f32 v70, v70
    v_exp_f32 v71, v71
    v_exp_f32 v40, v40
    v_exp_f32 v41, v41
    v_cvt_pk_bf16_f32 v78, v68, v69
    v_cvt_pk_bf16_f32 v79, v70, v71
    v_add_u32 v6, v6, v7
    ds_read_b128 v[104:107], v6 offset:0
    ds_read_b128 v[108:111], v6 offset:512
    v_exp_f32 v42, v42
    v_exp_f32 v43, v43
    v_mfma_f32_32x32x16_bf16 v[80:95], v[116:119], v[76:79], v[80:95]
    v_exp_f32 v44, v44
    v_exp_f32 v45, v45
    v_cvt_pk_bf16_f32 v72, v40, v41
    v_cvt_pk_bf16_f32 v73, v42, v43
    s_waitcnt lgkmcnt(2)
    v_mfma_f32_32x32x16_bf16 v[56:71], v[100:103], v[20:23], v[24:39]
    ds_read_b128 v[96:99], v3 offset:14336
    v_exp_f32 v46, v46
    v_exp_f32 v47, v47
    v_exp_f32 v48, v48
    v_exp_f32 v49, v49
    v_cvt_pk_bf16_f32 v74, v44, v45
    v_cvt_pk_bf16_f32 v75, v46, v47
    v_exp_f32 v50, v50
    v_exp_f32 v51, v51
    s_waitcnt lgkmcnt(1)
    v_mfma_f32_32x32x16_bf16 v[80:95], v[104:107], v[72:75], v[80:95]
    v_exp_f32 v52, v52
    v_exp_f32 v53, v53
    v_cvt_pk_bf16_f32 v76, v48, v49
    v_cvt_pk_bf16_f32 v77, v50, v51
    v_exp_f32 v54, v54
    v_exp_f32 v55, v55
    v_exp_f32 v56, v56
    v_exp_f32 v57, v57
    v_cvt_pk_bf16_f32 v78, v52, v53
    v_cvt_pk_bf16_f32 v79, v54, v55
    ds_read_b128 v[112:115], v6 offset:1024
    ds_read_b128 v[116:119], v6 offset:1536
    v_exp_f32 v58, v58
    v_exp_f32 v59, v59
    v_mfma_f32_32x32x16_bf16 v[80:95], v[108:111], v[76:79], v[80:95]
    v_exp_f32 v60, v60
    v_exp_f32 v61, v61
    v_cvt_pk_bf16_f32 v72, v56, v57
    v_cvt_pk_bf16_f32 v73, v58, v59
    s_waitcnt lgkmcnt(2)
    v_mfma_f32_32x32x16_bf16 v[40:55], v[96:99], v[20:23], v[24:39]
    ds_read_b128 v[100:103], v3 offset:15360
    v_exp_f32 v62, v62
    v_exp_f32 v63, v63
    v_exp_f32 v64, v64
    v_exp_f32 v65, v65
    v_cvt_pk_bf16_f32 v74, v60, v61
    v_cvt_pk_bf16_f32 v75, v62, v63
    v_exp_f32 v66, v66
    v_exp_f32 v67, v67
    s_waitcnt lgkmcnt(1)
    v_mfma_f32_32x32x16_bf16 v[80:95], v[112:115], v[72:75], v[80:95]
    v_exp_f32 v68, v68
    v_exp_f32 v69, v69
    v_cvt_pk_bf16_f32 v76, v64, v65
    v_cvt_pk_bf16_f32 v77, v66, v67
    v_exp_f32 v70, v70
    v_exp_f32 v71, v71
    v_exp_f32 v40, v40
    v_exp_f32 v41, v41
    v_cvt_pk_bf16_f32 v78, v68, v69
    v_cvt_pk_bf16_f32 v79, v70, v71
    ds_read_b128 v[104:107], v6 offset:2048
    ds_read_b128 v[108:111], v6 offset:2560
    v_exp_f32 v42, v42
    v_exp_f32 v43, v43
    v_mfma_f32_32x32x16_bf16 v[80:95], v[116:119], v[76:79], v[80:95]
    v_exp_f32 v44, v44
    v_exp_f32 v45, v45
    v_cvt_pk_bf16_f32 v72, v40, v41
    v_cvt_pk_bf16_f32 v73, v42, v43
    s_waitcnt lgkmcnt(2)
    v_mfma_f32_32x32x16_bf16 v[56:71], v[100:103], v[20:23], v[24:39]
    ds_read_b128 v[96:99], v3 offset:16384
    v_exp_f32 v46, v46
    v_exp_f32 v47, v47
    v_exp_f32 v48, v48
    v_exp_f32 v49, v49
    v_cvt_pk_bf16_f32 v74, v44, v45
    v_cvt_pk_bf16_f32 v75, v46, v47
    v_exp_f32 v50, v50
    v_exp_f32 v51, v51
    s_waitcnt lgkmcnt(1)
    v_mfma_f32_32x32x16_bf16 v[80:95], v[104:107], v[72:75], v[80:95]
    v_exp_f32 v52, v52
    v_exp_f32 v53, v53
    v_cvt_pk_bf16_f32 v76, v48, v49
    v_cvt_pk_bf16_f32 v77, v50, v51
    v_exp_f32 v54, v54
    v_exp_f32 v55, v55
    v_exp_f32 v56, v56
    v_exp_f32 v57, v57
    v_cvt_pk_bf16_f32 v78, v52, v53
    v_cvt_pk_bf16_f32 v79, v54, v55
    ds_read_b128 v[112:115], v6 offset:3072
    ds_read_b128 v[116:119], v6 offset:3584
    v_exp_f32 v58, v58
    v_exp_f32 v59, v59
    v_mfma_f32_32x32x16_bf16 v[80:95], v[108:111], v[76:79], v[80:95]
    v_exp_f32 v60, v60
    v_exp_f32 v61, v61
    v_cvt_pk_bf16_f32 v72, v56, v57
    v_cvt_pk_bf16_f32 v73, v58, v59
    s_waitcnt lgkmcnt(2)
    v_mfma_f32_32x32x16_bf16 v[40:55], v[96:99], v[20:23], v[24:39]
    ds_read_b128 v[100:103], v3 offset:17408
    v_exp_f32 v62, v62
    v_exp_f32 v63, v63
    v_exp_f32 v64, v64
    v_exp_f32 v65, v65
    v_cvt_pk_bf16_f32 v74, v60, v61
    v_cvt_pk_bf16_f32 v75, v62, v63
    v_exp_f32 v66, v66
    v_exp_f32 v67, v67
    s_waitcnt lgkmcnt(1)
    v_mfma_f32_32x32x16_bf16 v[80:95], v[112:115], v[72:75], v[80:95]
    v_exp_f32 v68, v68
    v_exp_f32 v69, v69
    v_cvt_pk_bf16_f32 v76, v64, v65
    v_cvt_pk_bf16_f32 v77, v66, v67
    v_exp_f32 v70, v70
    v_exp_f32 v71, v71
    v_exp_f32 v40, v40
    v_exp_f32 v41, v41
    v_cvt_pk_bf16_f32 v78, v68, v69
    v_cvt_pk_bf16_f32 v79, v70, v71
    v_add_u32 v6, v6, v7
    ds_read_b128 v[104:107], v6 offset:0
    ds_read_b128 v[108:111], v6 offset:512
    v_exp_f32 v42, v42
    v_exp_f32 v43, v43
    v_mfma_f32_32x32x16_bf16 v[80:95], v[116:119], v[76:79], v[80:95]
    v_exp_f32 v44, v44
    v_exp_f32 v45, v45
    v_cvt_pk_bf16_f32 v72, v40, v41
    v_cvt_pk_bf16_f32 v73, v42, v43
    s_waitcnt lgkmcnt(2)
    v_mfma_f32_32x32x16_bf16 v[56:71], v[100:103], v[20:23], v[24:39]
    ds_read_b128 v[96:99], v3 offset:18432
    v_exp_f32 v46, v46
    v_exp_f32 v47, v47
    v_exp_f32 v48, v48
    v_exp_f32 v49, v49
    v_cvt_pk_bf16_f32 v74, v44, v45
    v_cvt_pk_bf16_f32 v75, v46, v47
    v_exp_f32 v50, v50
    v_exp_f32 v51, v51
    s_waitcnt lgkmcnt(1)
    v_mfma_f32_32x32x16_bf16 v[80:95], v[104:107], v[72:75], v[80:95]
    v_exp_f32 v52, v52
    v_exp_f32 v53, v53
    v_cvt_pk_bf16_f32 v76, v48, v49
    v_cvt_pk_bf16_f32 v77, v50, v51
    v_exp_f32 v54, v54
    v_exp_f32 v55, v55
    v_exp_f32 v56, v56
    v_exp_f32 v57, v57
    v_cvt_pk_bf16_f32 v78, v52, v53
    v_cvt_pk_bf16_f32 v79, v54, v55
    ds_read_b128 v[112:115], v6 offset:1024
    ds_read_b128 v[116:119], v6 offset:1536
    v_exp_f32 v58, v58
    v_exp_f32 v59, v59
    v_mfma_f32_32x32x16_bf16 v[80:95], v[108:111], v[76:79], v[80:95]
    v_exp_f32 v60, v60
    v_exp_f32 v61, v61
    v_cvt_pk_bf16_f32 v72, v56, v57
    v_cvt_pk_bf16_f32 v73, v58, v59
    s_waitcnt lgkmcnt(2)
    v_mfma_f32_32x32x16_bf16 v[40:55], v[96:99], v[20:23], v[24:39]
    ds_read_b128 v[100:103], v3 offset:19456
    v_exp_f32 v62, v62
    v_exp_f32 v63, v63
    v_exp_f32 v64, v64
    v_exp_f32 v65, v65
    v_cvt_pk_bf16_f32 v74, v60, v61
    v_cvt_pk_bf16_f32 v75, v62, v63
    v_exp_f32 v66, v66
    v_exp_f32 v67, v67
    s_waitcnt lgkmcnt(1)
    v_mfma_f32_32x32x16_bf16 v[80:95], v[112:115], v[72:75], v[80:95]
    v_exp_f32 v68, v68
    v_exp_f32 v69, v69
    v_cvt_pk_bf16_f32 v76, v64, v65
    v_cvt_pk_bf16_f32 v77, v66, v67
    v_exp_f32 v70, v70
    v_exp_f32 v71, v71
    v_exp_f32 v40, v40
    v_exp_f32 v41, v41
    v_cvt_pk_bf16_f32 v78, v68, v69
    v_cvt_pk_bf16_f32 v79, v70, v71
    ds_read_b128 v[104:107], v6 offset:2048
    ds_read_b128 v[108:111], v6 offset:2560
    v_exp_f32 v42, v42
    v_exp_f32 v43, v43
    v_mfma_f32_32x32x16_bf16 v[80:95], v[116:119], v[76:79], v[80:95]
    v_exp_f32 v44, v44
    v_exp_f32 v45, v45
    v_cvt_pk_bf16_f32 v72, v40, v41
    v_cvt_pk_bf16_f32 v73, v42, v43
    s_waitcnt lgkmcnt(2)
    v_mfma_f32_32x32x16_bf16 v[56:71], v[100:103], v[20:23], v[24:39]
    ds_read_b128 v[96:99], v3 offset:20480
    v_exp_f32 v46, v46
    v_exp_f32 v47, v47
    v_exp_f32 v48, v48
    v_exp_f32 v49, v49
    v_cvt_pk_bf16_f32 v74, v44, v45
    v_cvt_pk_bf16_f32 v75, v46, v47
    v_exp_f32 v50, v50
    v_exp_f32 v51, v51
    s_waitcnt lgkmcnt(1)
    v_mfma_f32_32x32x16_bf16 v[80:95], v[104:107], v[72:75], v[80:95]
    v_exp_f32 v52, v52
    v_exp_f32 v53, v53
    v_cvt_pk_bf16_f32 v76, v48, v49
    v_cvt_pk_bf16_f32 v77, v50, v51
    v_exp_f32 v54, v54
    v_exp_f32 v55, v55
    v_exp_f32 v56, v56
    v_exp_f32 v57, v57
    v_cvt_pk_bf16_f32 v78, v52, v53
    v_cvt_pk_bf16_f32 v79, v54, v55
    ds_read_b128 v[112:115], v6 offset:3072
    ds_read_b128 v[116:119], v6 offset:3584
    v_exp_f32 v58, v58
    v_exp_f32 v59, v59
    v_mfma_f32_32x32x16_bf16 v[80:95], v[108:111], v[76:79], v[80:95]
    v_exp_f32 v60, v60
    v_exp_f32 v61, v61
    v_cvt_pk_bf16_f32 v72, v56, v57
    v_cvt_pk_bf16_f32 v73, v58, v59
    s_waitcnt lgkmcnt(2)
    v_mfma_f32_32x32x16_bf16 v[40:55], v[96:99], v[20:23], v[24:39]
    ds_read_b128 v[100:103], v3 offset:21504
    v_exp_f32 v62, v62
    v_exp_f32 v63, v63
    v_exp_f32 v64, v64
    v_exp_f32 v65, v65
    v_cvt_pk_bf16_f32 v74, v60, v61
    v_cvt_pk_bf16_f32 v75, v62, v63
    v_exp_f32 v66, v66
    v_exp_f32 v67, v67
    s_waitcnt lgkmcnt(1)
    v_mfma_f32_32x32x16_bf16 v[80:95], v[112:115], v[72:75], v[80:95]
    v_exp_f32 v68, v68
    v_exp_f32 v69, v69
    v_cvt_pk_bf16_f32 v76, v64, v65
    v_cvt_pk_bf16_f32 v77, v66, v67
    v_exp_f32 v70, v70
    v_exp_f32 v71, v71
    v_exp_f32 v40, v40
    v_exp_f32 v41, v41
    v_cvt_pk_bf16_f32 v78, v68, v69
    v_cvt_pk_bf16_f32 v79, v70, v71
    v_add_u32 v6, v6, v7
    ds_read_b128 v[104:107], v6 offset:0
    ds_read_b128 v[108:111], v6 offset:512
    v_exp_f32 v42, v42
    v_exp_f32 v43, v43
    v_mfma_f32_32x32x16_bf16 v[80:95], v[116:119], v[76:79], v[80:95]
    v_exp_f32 v44, v44
    v_exp_f32 v45, v45
    v_cvt_pk_bf16_f32 v72, v40, v41
    v_cvt_pk_bf16_f32 v73, v42, v43
    s_waitcnt lgkmcnt(2)
    v_mfma_f32_32x32x16_bf16 v[56:71], v[100:103], v[20:23], v[24:39]
    ds_read_b128 v[96:99], v3 offset:22528
    v_exp_f32 v46, v46
    v_exp_f32 v47, v47
    v_exp_f32 v48, v48
    v_exp_f32 v49, v49
    v_cvt_pk_bf16_f32 v74, v44, v45
    v_cvt_pk_bf16_f32 v75, v46, v47
    v_exp_f32 v50, v50
    v_exp_f32 v51, v51
    s_waitcnt lgkmcnt(1)
    v_mfma_f32_32x32x16_bf16 v[80:95], v[104:107], v[72:75], v[80:95]
    v_exp_f32 v52, v52
    v_exp_f32 v53, v53
    v_cvt_pk_bf16_f32 v76, v48, v49
    v_cvt_pk_bf16_f32 v77, v50, v51
    v_exp_f32 v54, v54
    v_exp_f32 v55, v55
    v_exp_f32 v56, v56
    v_exp_f32 v57, v57
    v_cvt_pk_bf16_f32 v78, v52, v53
    v_cvt_pk_bf16_f32 v79, v54, v55
    ds_read_b128 v[112:115], v6 offset:1024
    ds_read_b128 v[116:119], v6 offset:1536
    v_exp_f32 v58, v58
    v_exp_f32 v59, v59
    v_mfma_f32_32x32x16_bf16 v[80:95], v[108:111], v[76:79], v[80:95]
    s_waitcnt vmcnt(0)
    s_cmp_eq_u32 s57, 0
    s_cbranch_scc1 L_sequential_preLN__softmax_full_mha__swiglu_ffn__prompt_sidef_done_27
    v_lshrrev_b32 v124, 5, v1
    v_lshlrev_b32 v124, 9, v124
    v_bfe_u32 v125, v1, 2, 2
    v_lshlrev_b32 v125, 7, v125
    v_add_u32 v124, v124, v125
    v_and_b32 v125, 3, v1
    v_lshlrev_b32 v125, 3, v125
    v_add_u32 v124, v124, v125
    v_add_u32 v124, s64, v124
    v_bfe_u32 v125, v1, 3, 1
    v_lshlrev_b32 v125, 1, v125
    s_cmp_eq_u32 s57, 3
    s_cbranch_scc1 L_sequential_preLN__softmax_full_mha__swiglu_ffn__prompt_sidef_gu_28
    v_bfe_u32 v120, v1, 4, 1
    v_or_b32 v120, 0, v120
    v_xor_b32 v120, v120, v125
    v_lshlrev_b32 v120, 5, v120
    v_add_u32 v120, v120, v124
    v_bfe_u32 v121, v1, 4, 1
    v_or_b32 v121, 2, v121
    v_xor_b32 v121, v121, v125
    v_lshlrev_b32 v121, 5, v121
    v_add_u32 v121, v121, v124
    ds_read_b64_tr_b16 v[128:129], v120 offset:0
    ds_read_b64_tr_b16 v[130:131], v120 offset:1024
    ds_read_b64_tr_b16 v[132:133], v120 offset:2048
    ds_read_b64_tr_b16 v[134:135], v120 offset:3072
    ds_read_b64_tr_b16 v[136:137], v120 offset:4096
    ds_read_b64_tr_b16 v[138:139], v120 offset:5120
    ds_read_b64_tr_b16 v[140:141], v120 offset:6144
    ds_read_b64_tr_b16 v[142:143], v120 offset:7168
    ds_read_b64_tr_b16 v[144:145], v121 offset:0
    ds_read_b64_tr_b16 v[146:147], v121 offset:1024
    ds_read_b64_tr_b16 v[148:149], v121 offset:2048
    ds_read_b64_tr_b16 v[150:151], v121 offset:3072
    ds_read_b64_tr_b16 v[152:153], v121 offset:4096
    ds_read_b64_tr_b16 v[154:155], v121 offset:5120
    ds_read_b64_tr_b16 v[156:157], v121 offset:6144
    ds_read_b64_tr_b16 v[158:159], v121 offset:7168
    s_mul_i32 s65, s63, 0
    s_add_u32 s65, s65, s62
    s_waitcnt lgkmcnt(14)
    buffer_store_dwordx4 v[128:131], v2, s[8:11], s65 offen offset:0 sc1
    s_waitcnt lgkmcnt(12)
    buffer_store_dwordx4 v[132:135], v2, s[8:11], s65 offen offset:1024 sc1
    s_waitcnt lgkmcnt(10)
    buffer_store_dwordx4 v[136:139], v2, s[8:11], s65 offen offset:2048 sc1
    s_waitcnt lgkmcnt(8)
    buffer_store_dwordx4 v[140:143], v2, s[8:11], s65 offen offset:3072 sc1
    s_mul_i32 s65, s63, 1
    s_add_u32 s65, s65, s62
    s_waitcnt lgkmcnt(6)
    buffer_store_dwordx4 v[144:147], v2, s[8:11], s65 offen offset:0 sc1
    s_waitcnt lgkmcnt(4)
    buffer_store_dwordx4 v[148:151], v2, s[8:11], s65 offen offset:1024 sc1
    s_waitcnt lgkmcnt(2)
    buffer_store_dwordx4 v[152:155], v2, s[8:11], s65 offen offset:2048 sc1
    s_waitcnt lgkmcnt(0)
    buffer_store_dwordx4 v[156:159], v2, s[8:11], s65 offen offset:3072 sc1
    s_branch L_sequential_preLN__softmax_full_mha__swiglu_ffn__prompt_sidef_done_27
L_sequential_preLN__softmax_full_mha__swiglu_ffn__prompt_sidef_gu_28:
    v_bfe_u32 v120, v1, 4, 1
    v_lshlrev_b32 v120, 12, v120
    v_add_u32 v124, v124, v120
    v_xor_b32 v120, 0, v125
    v_lshlrev_b32 v120, 5, v120
    v_add_u32 v120, v120, v124
    v_xor_b32 v121, 1, v125
    v_lshlrev_b32 v121, 5, v121
    v_add_u32 v121, v121, v124
    v_xor_b32 v122, 2, v125
    v_lshlrev_b32 v122, 5, v122
    v_add_u32 v122, v122, v124
    v_xor_b32 v123, 3, v125
    v_lshlrev_b32 v123, 5, v123
    v_add_u32 v123, v123, v124
    ds_read_b64_tr_b16 v[128:129], v120 offset:0
    ds_read_b64_tr_b16 v[130:131], v120 offset:1024
    ds_read_b64_tr_b16 v[132:133], v120 offset:2048
    ds_read_b64_tr_b16 v[134:135], v120 offset:3072
    ds_read_b64_tr_b16 v[136:137], v121 offset:0
    ds_read_b64_tr_b16 v[138:139], v121 offset:1024
    ds_read_b64_tr_b16 v[140:141], v121 offset:2048
    ds_read_b64_tr_b16 v[142:143], v121 offset:3072
    ds_read_b64_tr_b16 v[144:145], v122 offset:0
    ds_read_b64_tr_b16 v[146:147], v122 offset:1024
    ds_read_b64_tr_b16 v[148:149], v122 offset:2048
    ds_read_b64_tr_b16 v[150:151], v122 offset:3072
    ds_read_b64_tr_b16 v[152:153], v123 offset:0
    ds_read_b64_tr_b16 v[154:155], v123 offset:1024
    ds_read_b64_tr_b16 v[156:157], v123 offset:2048
    ds_read_b64_tr_b16 v[158:159], v123 offset:3072
    s_add_u32 s65, s62, 0
    s_waitcnt lgkmcnt(14)
    buffer_store_dwordx4 v[128:131], v2, s[8:11], s65 offen offset:0 sc1
    s_waitcnt lgkmcnt(12)
    buffer_store_dwordx4 v[132:135], v2, s[8:11], s65 offen offset:1024 sc1
    s_add_u32 s65, s62, 32768
    s_waitcnt lgkmcnt(10)
    buffer_store_dwordx4 v[136:139], v2, s[8:11], s65 offen offset:0 sc1
    s_waitcnt lgkmcnt(8)
    buffer_store_dwordx4 v[140:143], v2, s[8:11], s65 offen offset:1024 sc1
    s_add_u32 s65, s62, 65536
    s_waitcnt lgkmcnt(6)
    buffer_store_dwordx4 v[144:147], v2, s[8:11], s65 offen offset:0 sc1
    s_waitcnt lgkmcnt(4)
    buffer_store_dwordx4 v[148:151], v2, s[8:11], s65 offen offset:1024 sc1
    s_add_u32 s65, s62, 98304
    s_waitcnt lgkmcnt(2)
    buffer_store_dwordx4 v[152:155], v2, s[8:11], s65 offen offset:0 sc1
    s_waitcnt lgkmcnt(0)
    buffer_store_dwordx4 v[156:159], v2, s[8:11], s65 offen offset:1024 sc1
    v_mov_b32 v120, 0x3f803f80
    s_lshl_b32 s65, s59, 13
    s_lshl_b32 s66, s60, 7
    s_add_u32 s65, s65, s66
    s_add_u32 s65, s65, 22544384
    v_and_b32 v121, 31, v1
    v_lshlrev_b32 v121, 2, v121
    v_dot2_f32_bf16 v124, v128, v120, 0
    v_dot2_f32_bf16 v125, v136, v120, 0
    v_dot2_f32_bf16 v122, v144, v120, 0
    v_dot2_f32_bf16 v123, v152, v120, 0
    v_dot2_f32_bf16 v124, v129, v120, v124
    v_dot2_f32_bf16 v125, v137, v120, v125
    v_dot2_f32_bf16 v122, v145, v120, v122
    v_dot2_f32_bf16 v123, v153, v120, v123
    v_dot2_f32_bf16 v124, v130, v120, v124
    v_dot2_f32_bf16 v125, v138, v120, v125
    v_dot2_f32_bf16 v122, v146, v120, v122
    v_dot2_f32_bf16 v123, v154, v120, v123
    v_dot2_f32_bf16 v124, v131, v120, v124
    v_dot2_f32_bf16 v125, v139, v120, v125
    v_dot2_f32_bf16 v122, v147, v120, v122
    v_dot2_f32_bf16 v123, v155, v120, v123
    v_dot2_f32_bf16 v124, v132, v120, v124
    v_dot2_f32_bf16 v125, v140, v120, v125
    v_dot2_f32_bf16 v122, v148, v120, v122
    v_dot2_f32_bf16 v123, v156, v120, v123
    v_dot2_f32_bf16 v124, v133, v120, v124
    v_dot2_f32_bf16 v125, v141, v120, v125
    v_dot2_f32_bf16 v122, v149, v120, v122
    v_dot2_f32_bf16 v123, v157, v120, v123
    v_dot2_f32_bf16 v124, v134, v120, v124
    v_dot2_f32_bf16 v125, v142, v120, v125
    v_dot2_f32_bf16 v122, v150, v120, v122
    v_dot2_f32_bf16 v123, v158, v120, v123
    v_dot2_f32_bf16 v124, v135, v120, v124
    v_dot2_f32_bf16 v125, v143, v120, v125
    v_dot2_f32_bf16 v122, v151, v120, v122
    v_dot2_f32_bf16 v123, v159, v120, v123
    s_nop 2
    v_mov_b32 v126, v124
    v_mov_b32 v127, v124
    s_nop 1
    v_permlane32_swap_b32 v126, v127
    v_add_f32 v124, v126, v127
    v_mov_b32 v126, v125
    v_mov_b32 v127, v125
    s_nop 1
    v_permlane32_swap_b32 v126, v127
    v_add_f32 v125, v126, v127
    v_mov_b32 v126, v122
    v_mov_b32 v127, v122
    s_nop 1
    v_permlane32_swap_b32 v126, v127
    v_add_f32 v122, v126, v127
    v_mov_b32 v126, v123
    v_mov_b32 v127, v123
    s_nop 1
    v_permlane32_swap_b32 v126, v127
    v_add_f32 v123, v126, v127
    s_add_u32 s66, s65, 0
    buffer_store_dword v124, v121, s[8:11], s66 offen sc1
    s_add_u32 s66, s65, 2048
    buffer_store_dword v125, v121, s[8:11], s66 offen sc1
    s_add_u32 s66, s65, 4096
    buffer_store_dword v122, v121, s[8:11], s66 offen sc1
    s_add_u32 s66, s65, 6144
    buffer_store_dword v123, v121, s[8:11], s66 offen sc1
L_sequential_preLN__softmax_full_mha__swiglu_ffn__prompt_sidef_done_27:
    v_exp_f32 v60, v60
    v_exp_f32 v61, v61
    v_cvt_pk_bf16_f32 v72, v56, v57
    v_cvt_pk_bf16_f32 v73, v58, v59
    s_waitcnt lgkmcnt(2)
    v_mfma_f32_32x32x16_bf16 v[40:55], v[96:99], v[20:23], v[24:39]
    ds_read_b128 v[100:103], v3 offset:23552
    v_exp_f32 v62, v62
    v_exp_f32 v63, v63
    v_exp_f32 v64, v64
    v_exp_f32 v65, v65
    v_cvt_pk_bf16_f32 v74, v60, v61
    v_cvt_pk_bf16_f32 v75, v62, v63
    v_exp_f32 v66, v66
    v_exp_f32 v67, v67
    s_waitcnt lgkmcnt(1)
    v_mfma_f32_32x32x16_bf16 v[80:95], v[112:115], v[72:75], v[80:95]
    v_exp_f32 v68, v68
    v_exp_f32 v69, v69
    v_cvt_pk_bf16_f32 v76, v64, v65
    v_cvt_pk_bf16_f32 v77, v66, v67
    v_exp_f32 v70, v70
    v_exp_f32 v71, v71
    v_exp_f32 v40, v40
    v_exp_f32 v41, v41
    v_cvt_pk_bf16_f32 v78, v68, v69
    v_cvt_pk_bf16_f32 v79, v70, v71
    ds_read_b128 v[104:107], v6 offset:2048
    ds_read_b128 v[108:111], v6 offset:2560
    v_exp_f32 v42, v42
    v_exp_f32 v43, v43
    v_mfma_f32_32x32x16_bf16 v[80:95], v[116:119], v[76:79], v[80:95]
    v_exp_f32 v44, v44
    v_exp_f32 v45, v45
    v_cvt_pk_bf16_f32 v72, v40, v41
    v_cvt_pk_bf16_f32 v73, v42, v43
    s_waitcnt lgkmcnt(2)
    v_mfma_f32_32x32x16_bf16 v[56:71], v[100:103], v[20:23], v[24:39]
    ds_read_b128 v[96:99], v3 offset:24576
    v_exp_f32 v46, v46
    v_exp_f32 v47, v47
    v_exp_f32 v48, v48
    v_exp_f32 v49, v49
    v_cvt_pk_bf16_f32 v74, v44, v45
    v_cvt_pk_bf16_f32 v75, v46, v47
    v_exp_f32 v50, v50
    v_exp_f32 v51, v51
    s_waitcnt lgkmcnt(1)
    v_mfma_f32_32x32x16_bf16 v[80:95], v[104:107], v[72:75], v[80:95]
    v_exp_f32 v52, v52
    v_exp_f32 v53, v53
    v_cvt_pk_bf16_f32 v76, v48, v49
    v_cvt_pk_bf16_f32 v77, v50, v51
    v_exp_f32 v54, v54
    v_exp_f32 v55, v55
    v_exp_f32 v56, v56
    v_exp_f32 v57, v57
    v_cvt_pk_bf16_f32 v78, v52, v53
    v_cvt_pk_bf16_f32 v79, v54, v55
    ds_read_b128 v[112:115], v6 offset:3072
    ds_read_b128 v[116:119], v6 offset:3584
    v_exp_f32 v58, v58
    v_exp_f32 v59, v59
    v_mfma_f32_32x32x16_bf16 v[80:95], v[108:111], v[76:79], v[80:95]
    v_exp_f32 v60, v60
    v_exp_f32 v61, v61
    v_cvt_pk_bf16_f32 v72, v56, v57
    v_cvt_pk_bf16_f32 v73, v58, v59
    s_waitcnt lgkmcnt(2)
    v_mfma_f32_32x32x16_bf16 v[40:55], v[96:99], v[20:23], v[24:39]
    ds_read_b128 v[100:103], v3 offset:25600
    v_exp_f32 v62, v62
    v_exp_f32 v63, v63
    v_exp_f32 v64, v64
    v_exp_f32 v65, v65
    v_cvt_pk_bf16_f32 v74, v60, v61
    v_cvt_pk_bf16_f32 v75, v62, v63
    v_exp_f32 v66, v66
    v_exp_f32 v67, v67
    s_waitcnt lgkmcnt(1)
    v_mfma_f32_32x32x16_bf16 v[80:95], v[112:115], v[72:75], v[80:95]
    v_exp_f32 v68, v68
    v_exp_f32 v69, v69
    v_cvt_pk_bf16_f32 v76, v64, v65
    v_cvt_pk_bf16_f32 v77, v66, v67
    v_exp_f32 v70, v70
    v_exp_f32 v71, v71
    v_exp_f32 v40, v40
    v_exp_f32 v41, v41
    v_cvt_pk_bf16_f32 v78, v68, v69
    v_cvt_pk_bf16_f32 v79, v70, v71
    v_add_u32 v6, v6, v7
    ds_read_b128 v[104:107], v6 offset:0
    ds_read_b128 v[108:111], v6 offset:512
    v_exp_f32 v42, v42
    v_exp_f32 v43, v43
    v_mfma_f32_32x32x16_bf16 v[80:95], v[116:119], v[76:79], v[80:95]
    v_exp_f32 v44, v44
    v_exp_f32 v45, v45
    v_cvt_pk_bf16_f32 v72, v40, v41
    v_cvt_pk_bf16_f32 v73, v42, v43
    s_waitcnt lgkmcnt(2)
    v_mfma_f32_32x32x16_bf16 v[56:71], v[100:103], v[20:23], v[24:39]
    ds_read_b128 v[96:99], v3 offset:26624
    v_exp_f32 v46, v46
    v_exp_f32 v47, v47
    v_exp_f32 v48, v48
    v_exp_f32 v49, v49
    v_cvt_pk_bf16_f32 v74, v44, v45
    v_cvt_pk_bf16_f32 v75, v46, v47
    v_exp_f32 v50, v50
    v_exp_f32 v51, v51
    s_waitcnt lgkmcnt(1)
    v_mfma_f32_32x32x16_bf16 v[80:95], v[104:107], v[72:75], v[80:95]
    v_exp_f32 v52, v52
    v_exp_f32 v53, v53
    v_cvt_pk_bf16_f32 v76, v48, v49
    v_cvt_pk_bf16_f32 v77, v50, v51
    v_exp_f32 v54, v54
    v_exp_f32 v55, v55
    v_exp_f32 v56, v56
    v_exp_f32 v57, v57
    v_cvt_pk_bf16_f32 v78, v52, v53
    v_cvt_pk_bf16_f32 v79, v54, v55
    ds_read_b128 v[112:115], v6 offset:1024
    ds_read_b128 v[116:119], v6 offset:1536
    v_exp_f32 v58, v58
    v_exp_f32 v59, v59
    v_mfma_f32_32x32x16_bf16 v[80:95], v[108:111], v[76:79], v[80:95]
    v_exp_f32 v60, v60
    v_exp_f32 v61, v61
    v_cvt_pk_bf16_f32 v72, v56, v57
    v_cvt_pk_bf16_f32 v73, v58, v59
    s_waitcnt lgkmcnt(2)
    v_mfma_f32_32x32x16_bf16 v[40:55], v[96:99], v[20:23], v[24:39]
    ds_read_b128 v[100:103], v3 offset:27648
    v_exp_f32 v62, v62
    v_exp_f32 v63, v63
    v_exp_f32 v64, v64
    v_exp_f32 v65, v65
    v_cvt_pk_bf16_f32 v74, v60, v61
    v_cvt_pk_bf16_f32 v75, v62, v63
    v_exp_f32 v66, v66
    v_exp_f32 v67, v67
    s_waitcnt lgkmcnt(1)
    v_mfma_f32_32x32x16_bf16 v[80:95], v[112:115], v[72:75], v[80:95]
    v_exp_f32 v68, v68
    v_exp_f32 v69, v69
    v_cvt_pk_bf16_f32 v76, v64, v65
    v_cvt_pk_bf16_f32 v77, v66, v67
    v_exp_f32 v70, v70
    v_exp_f32 v71, v71
    v_exp_f32 v40, v40
    v_exp_f32 v41, v41
    v_cvt_pk_bf16_f32 v78, v68, v69
    v_cvt_pk_bf16_f32 v79, v70, v71
    ds_read_b128 v[104:107], v6 offset:2048
    ds_read_b128 v[108:111], v6 offset:2560
    v_exp_f32 v42, v42
    v_exp_f32 v43, v43
    v_mfma_f32_32x32x16_bf16 v[80:95], v[116:119], v[76:79], v[80:95]
    v_exp_f32 v44, v44
    v_exp_f32 v45, v45
    v_cvt_pk_bf16_f32 v72, v40, v41
    v_cvt_pk_bf16_f32 v73, v42, v43
    s_waitcnt lgkmcnt(2)
    v_mfma_f32_32x32x16_bf16 v[56:71], v[100:103], v[20:23], v[24:39]
    ds_read_b128 v[96:99], v3 offset:28672
    v_exp_f32 v46, v46
    v_exp_f32 v47, v47
    v_exp_f32 v48, v48
    v_exp_f32 v49, v49
    v_cvt_pk_bf16_f32 v74, v44, v45
    v_cvt_pk_bf16_f32 v75, v46, v47
    v_exp_f32 v50, v50
    v_exp_f32 v51, v51
    s_waitcnt lgkmcnt(1)
    v_mfma_f32_32x32x16_bf16 v[80:95], v[104:107], v[72:75], v[80:95]
    v_exp_f32 v52, v52
    v_exp_f32 v53, v53
    v_cvt_pk_bf16_f32 v76, v48, v49
    v_cvt_pk_bf16_f32 v77, v50, v51
    v_exp_f32 v54, v54
    v_exp_f32 v55, v55
    v_exp_f32 v56, v56
    v_exp_f32 v57, v57
    v_cvt_pk_bf16_f32 v78, v52, v53
    v_cvt_pk_bf16_f32 v79, v54, v55
    ds_read_b128 v[112:115], v6 offset:3072
    ds_read_b128 v[116:119], v6 offset:3584
    v_exp_f32 v58, v58
    v_exp_f32 v59, v59
    v_mfma_f32_32x32x16_bf16 v[80:95], v[108:111], v[76:79], v[80:95]
    v_and_b32 v17, 31, v1
    v_lshlrev_b32 v17, 2, v17
    s_add_u32 s44, s6, 22945792
    buffer_load_dword v18, v17, s[8:11], s44 offen sc1
    v_exp_f32 v60, v60
    v_exp_f32 v61, v61
    v_cvt_pk_bf16_f32 v72, v56, v57
    v_cvt_pk_bf16_f32 v73, v58, v59
    s_waitcnt lgkmcnt(2)
    v_mfma_f32_32x32x16_bf16 v[40:55], v[96:99], v[20:23], v[24:39]
    ds_read_b128 v[100:103], v3 offset:29696
    v_exp_f32 v62, v62
    v_exp_f32 v63, v63
    v_exp_f32 v64, v64
    v_exp_f32 v65, v65
    v_cvt_pk_bf16_f32 v74, v60, v61
    v_cvt_pk_bf16_f32 v75, v62, v63
    v_exp_f32 v66, v66
    v_exp_f32 v67, v67
    s_waitcnt lgkmcnt(1)
    v_mfma_f32_32x32x16_bf16 v[80:95], v[112:115], v[72:75], v[80:95]
    v_exp_f32 v68, v68
    v_exp_f32 v69, v69
    v_cvt_pk_bf16_f32 v76, v64, v65
    v_cvt_pk_bf16_f32 v77, v66, v67
    v_exp_f32 v70, v70
    v_exp_f32 v71, v71
    v_exp_f32 v40, v40
    v_exp_f32 v41, v41
    v_cvt_pk_bf16_f32 v78, v68, v69
    v_cvt_pk_bf16_f32 v79, v70, v71
    v_add_u32 v6, v6, v7
    ds_read_b128 v[104:107], v6 offset:0
    ds_read_b128 v[108:111], v6 offset:512
    v_exp_f32 v42, v42
    v_exp_f32 v43, v43
    v_mfma_f32_32x32x16_bf16 v[80:95], v[116:119], v[76:79], v[80:95]
    v_exp_f32 v44, v44
    v_exp_f32 v45, v45
    v_cvt_pk_bf16_f32 v72, v40, v41
    v_cvt_pk_bf16_f32 v73, v42, v43
    s_waitcnt lgkmcnt(2)
    v_mfma_f32_32x32x16_bf16 v[56:71], v[100:103], v[20:23], v[24:39]
    ds_read_b128 v[96:99], v3 offset:30720
    v_exp_f32 v46, v46
    v_exp_f32 v47, v47
    v_exp_f32 v48, v48
    v_exp_f32 v49, v49
    v_cvt_pk_bf16_f32 v74, v44, v45
    v_cvt_pk_bf16_f32 v75, v46, v47
    v_exp_f32 v50, v50
    v_exp_f32 v51, v51
    s_waitcnt lgkmcnt(1)
    v_mfma_f32_32x32x16_bf16 v[80:95], v[104:107], v[72:75], v[80:95]
    v_exp_f32 v52, v52
    v_exp_f32 v53, v53
    v_cvt_pk_bf16_f32 v76, v48, v49
    v_cvt_pk_bf16_f32 v77, v50, v51
    v_exp_f32 v54, v54
    v_exp_f32 v55, v55
    v_exp_f32 v56, v56
    v_exp_f32 v57, v57
    v_cvt_pk_bf16_f32 v78, v52, v53
    v_cvt_pk_bf16_f32 v79, v54, v55
    ds_read_b128 v[112:115], v6 offset:1024
    ds_read_b128 v[116:119], v6 offset:1536
    v_exp_f32 v58, v58
    v_exp_f32 v59, v59
    v_mfma_f32_32x32x16_bf16 v[80:95], v[108:111], v[76:79], v[80:95]
    v_exp_f32 v60, v60
    v_exp_f32 v61, v61
    v_cvt_pk_bf16_f32 v72, v56, v57
    v_cvt_pk_bf16_f32 v73, v58, v59
    s_waitcnt lgkmcnt(2)
    v_mfma_f32_32x32x16_bf16 v[40:55], v[96:99], v[20:23], v[24:39]
    ds_read_b128 v[100:103], v3 offset:31744
    v_exp_f32 v62, v62
    v_exp_f32 v63, v63
    v_exp_f32 v64, v64
    v_exp_f32 v65, v65
    v_cvt_pk_bf16_f32 v74, v60, v61
    v_cvt_pk_bf16_f32 v75, v62, v63
    v_exp_f32 v66, v66
    v_exp_f32 v67, v67
    s_waitcnt lgkmcnt(1)
    v_mfma_f32_32x32x16_bf16 v[80:95], v[112:115], v[72:75], v[80:95]
    v_exp_f32 v68, v68
    v_exp_f32 v69, v69
    v_cvt_pk_bf16_f32 v76, v64, v65
    v_cvt_pk_bf16_f32 v77, v66, v67
    v_exp_f32 v70, v70
    v_exp_f32 v71, v71
    v_exp_f32 v40, v40
    v_exp_f32 v41, v41
    v_cvt_pk_bf16_f32 v78, v68, v69
    v_cvt_pk_bf16_f32 v79, v70, v71
    ds_read_b128 v[104:107], v6 offset:2048
    ds_read_b128 v[108:111], v6 offset:2560
    v_exp_f32 v42, v42
    v_exp_f32 v43, v43
    v_mfma_f32_32x32x16_bf16 v[80:95], v[116:119], v[76:79], v[80:95]
    v_exp_f32 v44, v44
    v_exp_f32 v45, v45
    v_cvt_pk_bf16_f32 v72, v40, v41
    v_cvt_pk_bf16_f32 v73, v42, v43
    s_waitcnt lgkmcnt(2)
    v_mfma_f32_32x32x16_bf16 v[56:71], v[100:103], v[20:23], v[24:39]
    ds_read_b128 v[96:99], v3 offset:32768
    v_exp_f32 v46, v46
    v_exp_f32 v47, v47
    v_exp_f32 v48, v48
    v_exp_f32 v49, v49
    v_cvt_pk_bf16_f32 v74, v44, v45
    v_cvt_pk_bf16_f32 v75, v46, v47
    v_exp_f32 v50, v50
    v_exp_f32 v51, v51
    s_waitcnt lgkmcnt(1)
    v_mfma_f32_32x32x16_bf16 v[80:95], v[104:107], v[72:75], v[80:95]
    v_exp_f32 v52, v52
    v_exp_f32 v53, v53
    v_cvt_pk_bf16_f32 v76, v48, v49
    v_cvt_pk_bf16_f32 v77, v50, v51
    v_exp_f32 v54, v54
    v_exp_f32 v55, v55
    v_exp_f32 v56, v56
    v_exp_f32 v57, v57
    v_cvt_pk_bf16_f32 v78, v52, v53
    v_cvt_pk_bf16_f32 v79, v54, v55
    ds_read_b128 v[112:115], v6 offset:3072
    ds_read_b128 v[116:119], v6 offset:3584
    v_exp_f32 v58, v58
    v_exp_f32 v59, v59
    v_mfma_f32_32x32x16_bf16 v[80:95], v[108:111], v[76:79], v[80:95]
    v_exp_f32 v60, v60
    v_exp_f32 v61, v61
    v_cvt_pk_bf16_f32 v72, v56, v57
    v_cvt_pk_bf16_f32 v73, v58, v59
    s_waitcnt lgkmcnt(2)
    v_mfma_f32_32x32x16_bf16 v[40:55], v[96:99], v[20:23], v[24:39]
    ds_read_b128 v[100:103], v3 offset:33792
    v_exp_f32 v62, v62
    v_exp_f32 v63, v63
    v_exp_f32 v64, v64
    v_exp_f32 v65, v65
    v_cvt_pk_bf16_f32 v74, v60, v61
    v_cvt_pk_bf16_f32 v75, v62, v63
    v_exp_f32 v66, v66
    v_exp_f32 v67, v67
    s_waitcnt lgkmcnt(1)
    v_mfma_f32_32x32x16_bf16 v[80:95], v[112:115], v[72:75], v[80:95]
    v_exp_f32 v68, v68
    v_exp_f32 v69, v69
    v_cvt_pk_bf16_f32 v76, v64, v65
    v_cvt_pk_bf16_f32 v77, v66, v67
    v_exp_f32 v70, v70
    v_exp_f32 v71, v71
    v_exp_f32 v40, v40
    v_exp_f32 v41, v41
    v_cvt_pk_bf16_f32 v78, v68, v69
    v_cvt_pk_bf16_f32 v79, v70, v71
    v_add_u32 v6, v6, v7
    ds_read_b128 v[104:107], v6 offset:0
    ds_read_b128 v[108:111], v6 offset:512
    v_exp_f32 v42, v42
    v_exp_f32 v43, v43
    v_mfma_f32_32x32x16_bf16 v[80:95], v[116:119], v[76:79], v[80:95]
    v_exp_f32 v44, v44
    v_exp_f32 v45, v45
    v_cvt_pk_bf16_f32 v72, v40, v41
    v_cvt_pk_bf16_f32 v73, v42, v43
    s_waitcnt lgkmcnt(2)
    v_mfma_f32_32x32x16_bf16 v[56:71], v[100:103], v[20:23], v[24:39]
    ds_read_b128 v[96:99], v3 offset:34816
    v_exp_f32 v46, v46
    v_exp_f32 v47, v47
    v_exp_f32 v48, v48
    v_exp_f32 v49, v49
    v_cvt_pk_bf16_f32 v74, v44, v45
    v_cvt_pk_bf16_f32 v75, v46, v47
    v_exp_f32 v50, v50
    v_exp_f32 v51, v51
    s_waitcnt lgkmcnt(1)
    v_mfma_f32_32x32x16_bf16 v[80:95], v[104:107], v[72:75], v[80:95]
    v_exp_f32 v52, v52
    v_exp_f32 v53, v53
    v_cvt_pk_bf16_f32 v76, v48, v49
    v_cvt_pk_bf16_f32 v77, v50, v51
    v_exp_f32 v54, v54
    v_exp_f32 v55, v55
    v_exp_f32 v56, v56
    v_exp_f32 v57, v57
    v_cvt_pk_bf16_f32 v78, v52, v53
    v_cvt_pk_bf16_f32 v79, v54, v55
    ds_read_b128 v[112:115], v6 offset:1024
    ds_read_b128 v[116:119], v6 offset:1536
    v_exp_f32 v58, v58
    v_exp_f32 v59, v59
    v_mfma_f32_32x32x16_bf16 v[80:95], v[108:111], v[76:79], v[80:95]
    v_exp_f32 v60, v60
    v_exp_f32 v61, v61
    v_cvt_pk_bf16_f32 v72, v56, v57
    v_cvt_pk_bf16_f32 v73, v58, v59
    s_waitcnt lgkmcnt(2)
    v_mfma_f32_32x32x16_bf16 v[40:55], v[96:99], v[20:23], v[24:39]
    ds_read_b128 v[100:103], v3 offset:35840
    v_exp_f32 v62, v62
    v_exp_f32 v63, v63
    v_exp_f32 v64, v64
    v_exp_f32 v65, v65
    v_cvt_pk_bf16_f32 v74, v60, v61
    v_cvt_pk_bf16_f32 v75, v62, v63
    v_exp_f32 v66, v66
    v_exp_f32 v67, v67
    s_waitcnt lgkmcnt(1)
    v_mfma_f32_32x32x16_bf16 v[80:95], v[112:115], v[72:75], v[80:95]
    v_exp_f32 v68, v68
    v_exp_f32 v69, v69
    v_cvt_pk_bf16_f32 v76, v64, v65
    v_cvt_pk_bf16_f32 v77, v66, v67
    v_exp_f32 v70, v70
    v_exp_f32 v71, v71
    v_exp_f32 v40, v40
    v_exp_f32 v41, v41
    v_cvt_pk_bf16_f32 v78, v68, v69
    v_cvt_pk_bf16_f32 v79, v70, v71
    ds_read_b128 v[104:107], v6 offset:2048
    ds_read_b128 v[108:111], v6 offset:2560
    v_exp_f32 v42, v42
    v_exp_f32 v43, v43
    v_mfma_f32_32x32x16_bf16 v[80:95], v[116:119], v[76:79], v[80:95]
    s_cmp_ge_u32 s3, 3
    s_cbranch_scc1 L_sequential_preLN__softmax_full_mha__swiglu_ffn__prompt_nosd_29
    s_waitcnt vmcnt(0)
    s_lshl_b32 s7, s3, 10
    s_lshl_b32 s44, s2, 2
    s_add_u32 s7, s7, s44
    s_add_u32 s7, s7, 22941696
    v_mov_b32 v16, 1
    v_mov_b32 v17, 0
    s_mov_b64 exec, 1
    buffer_store_dword v16, v17, s[8:11], s7 offen sc1
    s_mov_b64 exec, -1
L_sequential_preLN__softmax_full_mha__swiglu_ffn__prompt_nosd_29:
    v_exp_f32 v44, v44
    v_exp_f32 v45, v45
    v_cvt_pk_bf16_f32 v72, v40, v41
    v_cvt_pk_bf16_f32 v73, v42, v43
    s_waitcnt lgkmcnt(2)
    v_mfma_f32_32x32x16_bf16 v[56:71], v[100:103], v[20:23], v[24:39]
    ds_read_b128 v[96:99], v3 offset:36864
    v_exp_f32 v46, v46
    v_exp_f32 v47, v47
    v_exp_f32 v48, v48
    v_exp_f32 v49, v49
    v_cvt_pk_bf16_f32 v74, v44, v45
    v_cvt_pk_bf16_f32 v75, v46, v47
    v_exp_f32 v50, v50
    v_exp_f32 v51, v51
    s_waitcnt lgkmcnt(1)
    v_mfma_f32_32x32x16_bf16 v[80:95], v[104:107], v[72:75], v[80:95]
    v_exp_f32 v52, v52
    v_exp_f32 v53, v53
    v_cvt_pk_bf16_f32 v76, v48, v49
    v_cvt_pk_bf16_f32 v77, v50, v51
    v_exp_f32 v54, v54
    v_exp_f32 v55, v55
    v_exp_f32 v56, v56
    v_exp_f32 v57, v57
    v_cvt_pk_bf16_f32 v78, v52, v53
    v_cvt_pk_bf16_f32 v79, v54, v55
    ds_read_b128 v[112:115], v6 offset:3072
    ds_read_b128 v[116:119], v6 offset:3584
    v_exp_f32 v58, v58
    v_exp_f32 v59, v59
    v_mfma_f32_32x32x16_bf16 v[80:95], v[108:111], v[76:79], v[80:95]
    v_exp_f32 v60, v60
    v_exp_f32 v61, v61
    v_cvt_pk_bf16_f32 v72, v56, v57
    v_cvt_pk_bf16_f32 v73, v58, v59
    s_waitcnt lgkmcnt(2)
    v_mfma_f32_32x32x16_bf16 v[40:55], v[96:99], v[20:23], v[24:39]
    ds_read_b128 v[100:103], v3 offset:37888
    v_exp_f32 v62, v62
    v_exp_f32 v63, v63
    v_exp_f32 v64, v64
    v_exp_f32 v65, v65
    v_cvt_pk_bf16_f32 v74, v60, v61
    v_cvt_pk_bf16_f32 v75, v62, v63
    v_exp_f32 v66, v66
    v_exp_f32 v67, v67
    s_waitcnt lgkmcnt(1)
    v_mfma_f32_32x32x16_bf16 v[80:95], v[112:115], v[72:75], v[80:95]
    v_exp_f32 v68, v68
    v_exp_f32 v69, v69
    v_cvt_pk_bf16_f32 v76, v64, v65
    v_cvt_pk_bf16_f32 v77, v66, v67
    v_exp_f32 v70, v70
    v_exp_f32 v71, v71
    v_exp_f32 v40, v40
    v_exp_f32 v41, v41
    v_cvt_pk_bf16_f32 v78, v68, v69
    v_cvt_pk_bf16_f32 v79, v70, v71
    v_add_u32 v6, v6, v7
    ds_read_b128 v[104:107], v6 offset:0
    ds_read_b128 v[108:111], v6 offset:512
    v_exp_f32 v42, v42
    v_exp_f32 v43, v43
    v_mfma_f32_32x32x16_bf16 v[80:95], v[116:119], v[76:79], v[80:95]
    v_exp_f32 v44, v44
    v_exp_f32 v45, v45
    v_cvt_pk_bf16_f32 v72, v40, v41
    v_cvt_pk_bf16_f32 v73, v42, v43
    s_waitcnt lgkmcnt(2)
    v_mfma_f32_32x32x16_bf16 v[56:71], v[100:103], v[20:23], v[24:39]
    ds_read_b128 v[96:99], v3 offset:38912
    v_exp_f32 v46, v46
    v_exp_f32 v47, v47
    v_exp_f32 v48, v48
    v_exp_f32 v49, v49
    v_cvt_pk_bf16_f32 v74, v44, v45
    v_cvt_pk_bf16_f32 v75, v46, v47
    v_exp_f32 v50, v50
    v_exp_f32 v51, v51
    s_waitcnt lgkmcnt(1)
    v_mfma_f32_32x32x16_bf16 v[80:95], v[104:107], v[72:75], v[80:95]
    v_exp_f32 v52, v52
    v_exp_f32 v53, v53
    v_cvt_pk_bf16_f32 v76, v48, v49
    v_cvt_pk_bf16_f32 v77, v50, v51
    v_exp_f32 v54, v54
    v_exp_f32 v55, v55
    v_exp_f32 v56, v56
    v_exp_f32 v57, v57
    v_cvt_pk_bf16_f32 v78, v52, v53
    v_cvt_pk_bf16_f32 v79, v54, v55
    ds_read_b128 v[112:115], v6 offset:1024
    ds_read_b128 v[116:119], v6 offset:1536
    v_exp_f32 v58, v58
    v_exp_f32 v59, v59
    v_mfma_f32_32x32x16_bf16 v[80:95], v[108:111], v[76:79], v[80:95]
    s_waitcnt vmcnt(0)
    v_cmp_ne_u32 vcc, s47, v18
    s_nop 4
    s_cmp_eq_u64 vcc, 0
    s_cselect_b32 s46, 1, 0
    v_exp_f32 v60, v60
    v_exp_f32 v61, v61
    v_cvt_pk_bf16_f32 v72, v56, v57
    v_cvt_pk_bf16_f32 v73, v58, v59
    s_waitcnt lgkmcnt(2)
    v_mfma_f32_32x32x16_bf16 v[40:55], v[96:99], v[20:23], v[24:39]
    ds_read_b128 v[100:103], v3 offset:39936
    v_exp_f32 v62, v62
    v_exp_f32 v63, v63
    v_exp_f32 v64, v64
    v_exp_f32 v65, v65
    v_cvt_pk_bf16_f32 v74, v60, v61
    v_cvt_pk_bf16_f32 v75, v62, v63
    v_exp_f32 v66, v66
    v_exp_f32 v67, v67
    s_waitcnt lgkmcnt(1)
    v_mfma_f32_32x32x16_bf16 v[80:95], v[112:115], v[72:75], v[80:95]
    v_exp_f32 v68, v68
    v_exp_f32 v69, v69
    v_cvt_pk_bf16_f32 v76, v64, v65
    v_cvt_pk_bf16_f32 v77, v66, v67
    v_exp_f32 v70, v70
    v_exp_f32 v71, v71
    v_exp_f32 v40, v40
    v_exp_f32 v41, v41
    v_cvt_pk_bf16_f32 v78, v68, v69
    v_cvt_pk_bf16_f32 v79, v70, v71
    ds_read_b128 v[104:107], v6 offset:2048
    ds_read_b128 v[108:111], v6 offset:2560
    v_exp_f32 v42, v42
    v_exp_f32 v43, v43
    v_mfma_f32_32x32x16_bf16 v[80:95], v[116:119], v[76:79], v[80:95]
    v_exp_f32 v44, v44
    v_exp_f32 v45, v45
    v_cvt_pk_bf16_f32 v72, v40, v41
    v_cvt_pk_bf16_f32 v73, v42, v43
    s_waitcnt lgkmcnt(2)
    v_mfma_f32_32x32x16_bf16 v[56:71], v[100:103], v[20:23], v[24:39]
    ds_read_b128 v[96:99], v3 offset:40960
    v_exp_f32 v46, v46
    v_exp_f32 v47, v47
    v_exp_f32 v48, v48
    v_exp_f32 v49, v49
    v_cvt_pk_bf16_f32 v74, v44, v45
    v_cvt_pk_bf16_f32 v75, v46, v47
    v_exp_f32 v50, v50
    v_exp_f32 v51, v51
    s_waitcnt lgkmcnt(1)
    v_mfma_f32_32x32x16_bf16 v[80:95], v[104:107], v[72:75], v[80:95]
    v_exp_f32 v52, v52
    v_exp_f32 v53, v53
    v_cvt_pk_bf16_f32 v76, v48, v49
    v_cvt_pk_bf16_f32 v77, v50, v51
    v_exp_f32 v54, v54
    v_exp_f32 v55, v55
    v_exp_f32 v56, v56
    v_exp_f32 v57, v57
    v_cvt_pk_bf16_f32 v78, v52, v53
    v_cvt_pk_bf16_f32 v79, v54, v55
    ds_read_b128 v[112:115], v6 offset:3072
    ds_read_b128 v[116:119], v6 offset:3584
    v_exp_f32 v58, v58
    v_exp_f32 v59, v59
    v_mfma_f32_32x32x16_bf16 v[80:95], v[108:111], v[76:79], v[80:95]
    v_exp_f32 v60, v60
    v_exp_f32 v61, v61
    v_cvt_pk_bf16_f32 v72, v56, v57
    v_cvt_pk_bf16_f32 v73, v58, v59
    s_waitcnt lgkmcnt(2)
    v_mfma_f32_32x32x16_bf16 v[40:55], v[96:99], v[20:23], v[24:39]
    ds_read_b128 v[100:103], v3 offset:41984
    v_exp_f32 v62, v62
    v_exp_f32 v63, v63
    v_exp_f32 v64, v64
    v_exp_f32 v65, v65
    v_cvt_pk_bf16_f32 v74, v60, v61
    v_cvt_pk_bf16_f32 v75, v62, v63
    v_exp_f32 v66, v66
    v_exp_f32 v67, v67
    s_waitcnt lgkmcnt(1)
    v_mfma_f32_32x32x16_bf16 v[80:95], v[112:115], v[72:75], v[80:95]
    v_exp_f32 v68, v68
    v_exp_f32 v69, v69
    v_cvt_pk_bf16_f32 v76, v64, v65
    v_cvt_pk_bf16_f32 v77, v66, v67
    v_exp_f32 v70, v70
    v_exp_f32 v71, v71
    v_exp_f32 v40, v40
    v_exp_f32 v41, v41
    v_cvt_pk_bf16_f32 v78, v68, v69
    v_cvt_pk_bf16_f32 v79, v70, v71
    v_add_u32 v6, v6, v7
    ds_read_b128 v[104:107], v6 offset:0
    ds_read_b128 v[108:111], v6 offset:512
    v_exp_f32 v42, v42
    v_exp_f32 v43, v43
    v_mfma_f32_32x32x16_bf16 v[80:95], v[116:119], v[76:79], v[80:95]
    s_setprio 2
    v_exp_f32 v44, v44
    v_exp_f32 v45, v45
    v_cvt_pk_bf16_f32 v72, v40, v41
    v_cvt_pk_bf16_f32 v73, v42, v43
    s_waitcnt lgkmcnt(2)
    v_mfma_f32_32x32x16_bf16 v[56:71], v[100:103], v[20:23], v[24:39]
    ds_read_b128 v[96:99], v3 offset:43008
    v_exp_f32 v46, v46
    v_exp_f32 v47, v47
    v_exp_f32 v48, v48
    v_exp_f32 v49, v49
    v_cvt_pk_bf16_f32 v74, v44, v45
    v_cvt_pk_bf16_f32 v75, v46, v47
    v_exp_f32 v50, v50
    v_exp_f32 v51, v51
    s_waitcnt lgkmcnt(1)
    v_mfma_f32_32x32x16_bf16 v[80:95], v[104:107], v[72:75], v[80:95]
    v_exp_f32 v52, v52
    v_exp_f32 v53, v53
    v_cvt_pk_bf16_f32 v76, v48, v49
    v_cvt_pk_bf16_f32 v77, v50, v51
    v_exp_f32 v54, v54
    v_exp_f32 v55, v55
    v_exp_f32 v56, v56
    v_exp_f32 v57, v57
    v_cvt_pk_bf16_f32 v78, v52, v53
    v_cvt_pk_bf16_f32 v79, v54, v55
    ds_read_b128 v[112:115], v6 offset:1024
    ds_read_b128 v[116:119], v6 offset:1536
    v_exp_f32 v58, v58
    v_exp_f32 v59, v59
    v_mfma_f32_32x32x16_bf16 v[80:95], v[108:111], v[76:79], v[80:95]
    s_mov_b32 s7, 22941696
    buffer_load_dwordx4 v[140:143], v2, s[8:11], s7 offen offset:0 sc1
    buffer_load_dwordx4 v[144:147], v2, s[8:11], s7 offen offset:1024 sc1
    buffer_load_dwordx4 v[148:151], v2, s[8:11], s7 offen offset:2048 sc1
    v_exp_f32 v60, v60
    v_exp_f32 v61, v61
    v_cvt_pk_bf16_f32 v72, v56, v57
    v_cvt_pk_bf16_f32 v73, v58, v59
    s_waitcnt lgkmcnt(2)
    v_mfma_f32_32x32x16_bf16 v[40:55], v[96:99], v[20:23], v[24:39]
    ds_read_b128 v[100:103], v3 offset:44032
    v_exp_f32 v62, v62
    v_exp_f32 v63, v63
    v_exp_f32 v64, v64
    v_exp_f32 v65, v65
    v_cvt_pk_bf16_f32 v74, v60, v61
    v_cvt_pk_bf16_f32 v75, v62, v63
    v_exp_f32 v66, v66
    v_exp_f32 v67, v67
    s_waitcnt lgkmcnt(1)
    v_mfma_f32_32x32x16_bf16 v[80:95], v[112:115], v[72:75], v[80:95]
    v_exp_f32 v68, v68
    v_exp_f32 v69, v69
    v_cvt_pk_bf16_f32 v76, v64, v65
    v_cvt_pk_bf16_f32 v77, v66, v67
    v_exp_f32 v70, v70
    v_exp_f32 v71, v71
    v_exp_f32 v40, v40
    v_exp_f32 v41, v41
    v_cvt_pk_bf16_f32 v78, v68, v69
    v_cvt_pk_bf16_f32 v79, v70, v71
    ds_read_b128 v[104:107], v6 offset:2048
    ds_read_b128 v[108:111], v6 offset:2560
    v_exp_f32 v42, v42
    v_exp_f32 v43, v43
    v_mfma_f32_32x32x16_bf16 v[80:95], v[116:119], v[76:79], v[80:95]
    v_exp_f32 v44, v44
    v_exp_f32 v45, v45
    v_cvt_pk_bf16_f32 v72, v40, v41
    v_cvt_pk_bf16_f32 v73, v42, v43
    s_waitcnt lgkmcnt(2)
    v_mfma_f32_32x32x16_bf16 v[56:71], v[100:103], v[20:23], v[24:39]
    ds_read_b128 v[96:99], v3 offset:45056
    v_exp_f32 v46, v46
    v_exp_f32 v47, v47
    v_exp_f32 v48, v48
    v_exp_f32 v49, v49
    v_cvt_pk_bf16_f32 v74, v44, v45
    v_cvt_pk_bf16_f32 v75, v46, v47
    v_exp_f32 v50, v50
    v_exp_f32 v51, v51
    s_waitcnt lgkmcnt(1)
    v_mfma_f32_32x32x16_bf16 v[80:95], v[104:107], v[72:75], v[80:95]
    v_exp_f32 v52, v52
    v_exp_f32 v53, v53
    v_cvt_pk_bf16_f32 v76, v48, v49
    v_cvt_pk_bf16_f32 v77, v50, v51
    v_exp_f32 v54, v54
    v_exp_f32 v55, v55
    v_exp_f32 v56, v56
    v_exp_f32 v57, v57
    v_cvt_pk_bf16_f32 v78, v52, v53
    v_cvt_pk_bf16_f32 v79, v54, v55
    ds_read_b128 v[112:115], v6 offset:3072
    ds_read_b128 v[116:119], v6 offset:3584
    v_exp_f32 v58, v58
    v_exp_f32 v59, v59
    v_mfma_f32_32x32x16_bf16 v[80:95], v[108:111], v[76:79], v[80:95]
    v_exp_f32 v60, v60
    v_exp_f32 v61, v61
    v_cvt_pk_bf16_f32 v72, v56, v57
    v_cvt_pk_bf16_f32 v73, v58, v59
    s_waitcnt lgkmcnt(2)
    v_mfma_f32_32x32x16_bf16 v[40:55], v[96:99], v[20:23], v[24:39]
    ds_read_b128 v[100:103], v3 offset:46080
    v_exp_f32 v62, v62
    v_exp_f32 v63, v63
    v_exp_f32 v64, v64
    v_exp_f32 v65, v65
    v_cvt_pk_bf16_f32 v74, v60, v61
    v_cvt_pk_bf16_f32 v75, v62, v63
    v_exp_f32 v66, v66
    v_exp_f32 v67, v67
    s_waitcnt lgkmcnt(1)
    v_mfma_f32_32x32x16_bf16 v[80:95], v[112:115], v[72:75], v[80:95]
    v_exp_f32 v68, v68
    v_exp_f32 v69, v69
    v_cvt_pk_bf16_f32 v76, v64, v65
    v_cvt_pk_bf16_f32 v77, v66, v67
    v_exp_f32 v70, v70
    v_exp_f32 v71, v71
    v_exp_f32 v40, v40
    v_exp_f32 v41, v41
    v_cvt_pk_bf16_f32 v78, v68, v69
    v_cvt_pk_bf16_f32 v79, v70, v71
    v_add_u32 v6, v6, v7
    ds_read_b128 v[104:107], v6 offset:0
    ds_read_b128 v[108:111], v6 offset:512
    v_exp_f32 v42, v42
    v_exp_f32 v43, v43
    v_mfma_f32_32x32x16_bf16 v[80:95], v[116:119], v[76:79], v[80:95]
    v_exp_f32 v44, v44
    v_exp_f32 v45, v45
    v_cvt_pk_bf16_f32 v72, v40, v41
    v_cvt_pk_bf16_f32 v73, v42, v43
    s_waitcnt lgkmcnt(2)
    v_mfma_f32_32x32x16_bf16 v[56:71], v[100:103], v[20:23], v[24:39]
    ds_read_b128 v[96:99], v3 offset:47104
    v_exp_f32 v46, v46
    v_exp_f32 v47, v47
    v_exp_f32 v48, v48
    v_exp_f32 v49, v49
    v_cvt_pk_bf16_f32 v74, v44, v45
    v_cvt_pk_bf16_f32 v75, v46, v47
    v_exp_f32 v50, v50
    v_exp_f32 v51, v51
    s_waitcnt lgkmcnt(1)
    v_mfma_f32_32x32x16_bf16 v[80:95], v[104:107], v[72:75], v[80:95]
    v_exp_f32 v52, v52
    v_exp_f32 v53, v53
    v_cvt_pk_bf16_f32 v76, v48, v49
    v_cvt_pk_bf16_f32 v77, v50, v51
    v_exp_f32 v54, v54
    v_exp_f32 v55, v55
    v_exp_f32 v56, v56
    v_exp_f32 v57, v57
    v_cvt_pk_bf16_f32 v78, v52, v53
    v_cvt_pk_bf16_f32 v79, v54, v55
    ds_read_b128 v[112:115], v6 offset:1024
    ds_read_b128 v[116:119], v6 offset:1536
    v_exp_f32 v58, v58
    v_exp_f32 v59, v59
    v_mfma_f32_32x32x16_bf16 v[80:95], v[108:111], v[76:79], v[80:95]
    v_exp_f32 v60, v60
    v_exp_f32 v61, v61
    v_cvt_pk_bf16_f32 v72, v56, v57
    v_cvt_pk_bf16_f32 v73, v58, v59
    s_waitcnt lgkmcnt(2)
    v_mfma_f32_32x32x16_bf16 v[40:55], v[96:99], v[20:23], v[24:39]
    ds_read_b128 v[100:103], v3 offset:48128
    v_exp_f32 v62, v62
    v_exp_f32 v63, v63
    v_exp_f32 v64, v64
    v_exp_f32 v65, v65
    v_cvt_pk_bf16_f32 v74, v60, v61
    v_cvt_pk_bf16_f32 v75, v62, v63
    v_exp_f32 v66, v66
    v_exp_f32 v67, v67
    s_waitcnt lgkmcnt(1)
    v_mfma_f32_32x32x16_bf16 v[80:95], v[112:115], v[72:75], v[80:95]
    v_exp_f32 v68, v68
    v_exp_f32 v69, v69
    v_cvt_pk_bf16_f32 v76, v64, v65
    v_cvt_pk_bf16_f32 v77, v66, v67
    v_exp_f32 v70, v70
    v_exp_f32 v71, v71
    v_exp_f32 v40, v40
    v_exp_f32 v41, v41
    v_cvt_pk_bf16_f32 v78, v68, v69
    v_cvt_pk_bf16_f32 v79, v70, v71
    ds_read_b128 v[104:107], v6 offset:2048
    ds_read_b128 v[108:111], v6 offset:2560
    v_exp_f32 v42, v42
    v_exp_f32 v43, v43
    v_mfma_f32_32x32x16_bf16 v[80:95], v[116:119], v[76:79], v[80:95]
    v_exp_f32 v44, v44
    v_exp_f32 v45, v45
    v_cvt_pk_bf16_f32 v72, v40, v41
    v_cvt_pk_bf16_f32 v73, v42, v43
    s_waitcnt lgkmcnt(2)
    v_mfma_f32_32x32x16_bf16 v[56:71], v[100:103], v[20:23], v[24:39]
    ds_read_b128 v[96:99], v3 offset:49152
    v_exp_f32 v46, v46
    v_exp_f32 v47, v47
    v_exp_f32 v48, v48
    v_exp_f32 v49, v49
    v_cvt_pk_bf16_f32 v74, v44, v45
    v_cvt_pk_bf16_f32 v75, v46, v47
    v_exp_f32 v50, v50
    v_exp_f32 v51, v51
    s_waitcnt lgkmcnt(1)
    v_mfma_f32_32x32x16_bf16 v[80:95], v[104:107], v[72:75], v[80:95]
    v_exp_f32 v52, v52
    v_exp_f32 v53, v53
    v_cvt_pk_bf16_f32 v76, v48, v49
    v_cvt_pk_bf16_f32 v77, v50, v51
    v_exp_f32 v54, v54
    v_exp_f32 v55, v55
    v_exp_f32 v56, v56
    v_exp_f32 v57, v57
    v_cvt_pk_bf16_f32 v78, v52, v53
    v_cvt_pk_bf16_f32 v79, v54, v55
    ds_read_b128 v[112:115], v6 offset:3072
    ds_read_b128 v[116:119], v6 offset:3584
    v_exp_f32 v58, v58
    v_exp_f32 v59, v59
    v_mfma_f32_32x32x16_bf16 v[80:95], v[108:111], v[76:79], v[80:95]
    v_exp_f32 v60, v60
    v_exp_f32 v61, v61
    v_cvt_pk_bf16_f32 v72, v56, v57
    v_cvt_pk_bf16_f32 v73, v58, v59
    s_waitcnt lgkmcnt(2)
    v_mfma_f32_32x32x16_bf16 v[40:55], v[96:99], v[20:23], v[24:39]
    ds_read_b128 v[100:103], v3 offset:50176
    v_exp_f32 v62, v62
    v_exp_f32 v63, v63
    v_exp_f32 v64, v64
    v_exp_f32 v65, v65
    v_cvt_pk_bf16_f32 v74, v60, v61
    v_cvt_pk_bf16_f32 v75, v62, v63
    v_exp_f32 v66, v66
    v_exp_f32 v67, v67
    s_waitcnt lgkmcnt(1)
    v_mfma_f32_32x32x16_bf16 v[80:95], v[112:115], v[72:75], v[80:95]
    v_exp_f32 v68, v68
    v_exp_f32 v69, v69
    v_cvt_pk_bf16_f32 v76, v64, v65
    v_cvt_pk_bf16_f32 v77, v66, v67
    v_exp_f32 v70, v70
    v_exp_f32 v71, v71
    v_exp_f32 v40, v40
    v_exp_f32 v41, v41
    v_cvt_pk_bf16_f32 v78, v68, v69
    v_cvt_pk_bf16_f32 v79, v70, v71
    v_add_u32 v6, v6, v7
    ds_read_b128 v[104:107], v6 offset:0
    ds_read_b128 v[108:111], v6 offset:512
    v_exp_f32 v42, v42
    v_exp_f32 v43, v43
    v_mfma_f32_32x32x16_bf16 v[80:95], v[116:119], v[76:79], v[80:95]
    s_mov_b32 s45, 0
L_sequential_preLN__softmax_full_mha__swiglu_ffn__prompt_fs_loop_31:
    s_waitcnt vmcnt(0)
    v_and_b32 v140, v140, v141
    v_and_b32 v140, v140, v142
    v_and_b32 v140, v140, v143
    v_and_b32 v140, v140, v144
    v_and_b32 v140, v140, v145
    v_and_b32 v140, v140, v146
    v_and_b32 v140, v140, v147
    v_and_b32 v140, v140, v148
    v_and_b32 v140, v140, v149
    v_and_b32 v140, v140, v150
    v_and_b32 v140, v140, v151
    v_cmp_ne_u32 vcc, 1, v140
    s_add_u32 s45, s45, 1
    s_cmp_gt_u32 s45, 1048576
    s_cbranch_scc1 L_sequential_preLN__softmax_full_mha__swiglu_ffn__prompt_fs_ok_30
    s_cbranch_vccz L_sequential_preLN__softmax_full_mha__swiglu_ffn__prompt_fs_ok_30
    s_mov_b32 s7, 22941696
    buffer_load_dwordx4 v[140:143], v2, s[8:11], s7 offen offset:0 sc1
    buffer_load_dwordx4 v[144:147], v2, s[8:11], s7 offen offset:1024 sc1
    buffer_load_dwordx4 v[148:151], v2, s[8:11], s7 offen offset:2048 sc1
    s_branch L_sequential_preLN__softmax_full_mha__swiglu_ffn__prompt_fs_loop_31
L_sequential_preLN__softmax_full_mha__swiglu_ffn__prompt_fs_ok_30:
    v_exp_f32 v44, v44
    v_exp_f32 v45, v45
    v_cvt_pk_bf16_f32 v72, v40, v41
    v_cvt_pk_bf16_f32 v73, v42, v43
    s_waitcnt lgkmcnt(2)
    v_mfma_f32_32x32x16_bf16 v[56:71], v[100:103], v[20:23], v[24:39]
    ds_read_b128 v[96:99], v3 offset:51200
    v_exp_f32 v46, v46
    v_exp_f32 v47, v47
    v_exp_f32 v48, v48
    v_exp_f32 v49, v49
    v_cvt_pk_bf16_f32 v74, v44, v45
    v_cvt_pk_bf16_f32 v75, v46, v47
    v_exp_f32 v50, v50
    v_exp_f32 v51, v51
    s_waitcnt lgkmcnt(1)
    v_mfma_f32_32x32x16_bf16 v[80:95], v[104:107], v[72:75], v[80:95]
    v_exp_f32 v52, v52
    v_exp_f32 v53, v53
    v_cvt_pk_bf16_f32 v76, v48, v49
    v_cvt_pk_bf16_f32 v77, v50, v51
    v_exp_f32 v54, v54
    v_exp_f32 v55, v55
    v_exp_f32 v56, v56
    v_exp_f32 v57, v57
    v_cvt_pk_bf16_f32 v78, v52, v53
    v_cvt_pk_bf16_f32 v79, v54, v55
    ds_read_b128 v[112:115], v6 offset:1024
    ds_read_b128 v[116:119], v6 offset:1536
    v_exp_f32 v58, v58
    v_exp_f32 v59, v59
    v_mfma_f32_32x32x16_bf16 v[80:95], v[108:111], v[76:79], v[80:95]
    v_exp_f32 v60, v60
    v_exp_f32 v61, v61
    v_cvt_pk_bf16_f32 v72, v56, v57
    v_cvt_pk_bf16_f32 v73, v58, v59
    s_waitcnt lgkmcnt(2)
    v_mfma_f32_32x32x16_bf16 v[40:55], v[96:99], v[20:23], v[24:39]
    ds_read_b128 v[100:103], v3 offset:52224
    v_exp_f32 v62, v62
    v_exp_f32 v63, v63
    v_exp_f32 v64, v64
    v_exp_f32 v65, v65
    v_cvt_pk_bf16_f32 v74, v60, v61
    v_cvt_pk_bf16_f32 v75, v62, v63
    v_exp_f32 v66, v66
    v_exp_f32 v67, v67
    s_waitcnt lgkmcnt(1)
    v_mfma_f32_32x32x16_bf16 v[80:95], v[112:115], v[72:75], v[80:95]
    v_exp_f32 v68, v68
    v_exp_f32 v69, v69
    v_cvt_pk_bf16_f32 v76, v64, v65
    v_cvt_pk_bf16_f32 v77, v66, v67
    v_exp_f32 v70, v70
    v_exp_f32 v71, v71
    v_exp_f32 v40, v40
    v_exp_f32 v41, v41
    v_cvt_pk_bf16_f32 v78, v68, v69
    v_cvt_pk_bf16_f32 v79, v70, v71
    ds_read_b128 v[104:107], v6 offset:2048
    ds_read_b128 v[108:111], v6 offset:2560
    v_exp_f32 v42, v42
    v_exp_f32 v43, v43
    v_mfma_f32_32x32x16_bf16 v[80:95], v[116:119], v[76:79], v[80:95]
    s_lshr_b32 s7, s2, 3
    s_lshl_b32 s7, s7, 3
    s_add_u32 s7, s7, s3
    s_mul_i32 s44, s7, 11264
    s_add_u32 s44, s44, 18874368
    v_lshlrev_b32 v140, 7, v1
    buffer_load_dword v141, v140, s[8:11], s44 offen
    s_add_u32 s44, s44, 8192
    v_add_u32 v142, s44, v140
    s_lshl_b32 s44, s7, 11
    s_add_u32 s44, s44, 16774144
    v_add_u32 v143, s44, v140
    v_cmp_gt_u32 vcc, 24, v1
    s_mul_i32 s44, s7, 768
    s_add_u32 s44, s44, 22539264
    v_cndmask_b32 v143, v143, v142, vcc
    v_add_u32 v142, s44, v140
    v_cmp_gt_u32 vcc, 40, v1
    s_nop 1
    v_cndmask_b32 v143, v142, v143, vcc
    buffer_load_dword v144, v143, s[8:11], 0 offen
    v_exp_f32 v44, v44
    v_exp_f32 v45, v45
    v_cvt_pk_bf16_f32 v72, v40, v41
    v_cvt_pk_bf16_f32 v73, v42, v43
    s_waitcnt lgkmcnt(2)
    v_mfma_f32_32x32x16_bf16 v[56:71], v[100:103], v[20:23], v[24:39]
    ds_read_b128 v[96:99], v3 offset:53248
    v_exp_f32 v46, v46
    v_exp_f32 v47, v47
    v_exp_f32 v48, v48
    v_exp_f32 v49, v49
    v_cvt_pk_bf16_f32 v74, v44, v45
    v_cvt_pk_bf16_f32 v75, v46, v47
    v_exp_f32 v50, v50
    v_exp_f32 v51, v51
    s_waitcnt lgkmcnt(1)
    v_mfma_f32_32x32x16_bf16 v[80:95], v[104:107], v[72:75], v[80:95]
    v_exp_f32 v52, v52
    v_exp_f32 v53, v53
    v_cvt_pk_bf16_f32 v76, v48, v49
    v_cvt_pk_bf16_f32 v77, v50, v51
    v_exp_f32 v54, v54
    v_exp_f32 v55, v55
    v_exp_f32 v56, v56
    v_exp_f32 v57, v57
    v_cvt_pk_bf16_f32 v78, v52, v53
    v_cvt_pk_bf16_f32 v79, v54, v55
    ds_read_b128 v[112:115], v6 offset:3072
    ds_read_b128 v[116:119], v6 offset:3584
    v_exp_f32 v58, v58
    v_exp_f32 v59, v59
    v_mfma_f32_32x32x16_bf16 v[80:95], v[108:111], v[76:79], v[80:95]
    v_exp_f32 v60, v60
    v_exp_f32 v61, v61
    v_cvt_pk_bf16_f32 v72, v56, v57
    v_cvt_pk_bf16_f32 v73, v58, v59
    s_waitcnt lgkmcnt(2)
    v_mfma_f32_32x32x16_bf16 v[40:55], v[96:99], v[20:23], v[24:39]
    ds_read_b128 v[100:103], v3 offset:54272
    v_exp_f32 v62, v62
    v_exp_f32 v63, v63
    v_exp_f32 v64, v64
    v_exp_f32 v65, v65
    v_cvt_pk_bf16_f32 v74, v60, v61
    v_cvt_pk_bf16_f32 v75, v62, v63
    v_exp_f32 v66, v66
    v_exp_f32 v67, v67
    s_waitcnt lgkmcnt(1)
    v_mfma_f32_32x32x16_bf16 v[80:95], v[112:115], v[72:75], v[80:95]
    v_exp_f32 v68, v68
    v_exp_f32 v69, v69
    v_cvt_pk_bf16_f32 v76, v64, v65
    v_cvt_pk_bf16_f32 v77, v66, v67
    v_exp_f32 v70, v70
    v_exp_f32 v71, v71
    v_exp_f32 v40, v40
    v_exp_f32 v41, v41
    v_cvt_pk_bf16_f32 v78, v68, v69
    v_cvt_pk_bf16_f32 v79, v70, v71
    v_add_u32 v6, v6, v7
    ds_read_b128 v[104:107], v6 offset:0
    ds_read_b128 v[108:111], v6 offset:512
    v_exp_f32 v42, v42
    v_exp_f32 v43, v43
    v_mfma_f32_32x32x16_bf16 v[80:95], v[116:119], v[76:79], v[80:95]
    s_setprio 1
    v_exp_f32 v44, v44
    v_exp_f32 v45, v45
    v_cvt_pk_bf16_f32 v72, v40, v41
    v_cvt_pk_bf16_f32 v73, v42, v43
    s_waitcnt lgkmcnt(2)
    v_mfma_f32_32x32x16_bf16 v[56:71], v[100:103], v[20:23], v[24:39]
    ds_read_b128 v[96:99], v3 offset:55296
    v_exp_f32 v46, v46
    v_exp_f32 v47, v47
    v_exp_f32 v48, v48
    v_exp_f32 v49, v49
    v_cvt_pk_bf16_f32 v74, v44, v45
    v_cvt_pk_bf16_f32 v75, v46, v47
    v_exp_f32 v50, v50
    v_exp_f32 v51, v51
    s_waitcnt lgkmcnt(1)
    v_mfma_f32_32x32x16_bf16 v[80:95], v[104:107], v[72:75], v[80:95]
    v_exp_f32 v52, v52
    v_exp_f32 v53, v53
    v_cvt_pk_bf16_f32 v76, v48, v49
    v_cvt_pk_bf16_f32 v77, v50, v51
    v_exp_f32 v54, v54
    v_exp_f32 v55, v55
    v_exp_f32 v56, v56
    v_exp_f32 v57, v57
    v_cvt_pk_bf16_f32 v78, v52, v53
    v_cvt_pk_bf16_f32 v79, v54, v55
    ds_read_b128 v[112:115], v6 offset:1024
    ds_read_b128 v[116:119], v6 offset:1536
    v_exp_f32 v58, v58
    v_exp_f32 v59, v59
    v_mfma_f32_32x32x16_bf16 v[80:95], v[108:111], v[76:79], v[80:95]
    v_exp_f32 v60, v60
    v_exp_f32 v61, v61
    v_cvt_pk_bf16_f32 v72, v56, v57
    v_cvt_pk_bf16_f32 v73, v58, v59
    s_waitcnt lgkmcnt(2)
    v_mfma_f32_32x32x16_bf16 v[40:55], v[96:99], v[20:23], v[24:39]
    ds_read_b128 v[100:103], v3 offset:56320
    v_exp_f32 v62, v62
    v_exp_f32 v63, v63
    v_exp_f32 v64, v64
    v_exp_f32 v65, v65
    v_cvt_pk_bf16_f32 v74, v60, v61
    v_cvt_pk_bf16_f32 v75, v62, v63
    v_exp_f32 v66, v66
    v_exp_f32 v67, v67
    s_waitcnt lgkmcnt(1)
    v_mfma_f32_32x32x16_bf16 v[80:95], v[112:115], v[72:75], v[80:95]
    v_exp_f32 v68, v68
    v_exp_f32 v69, v69
    v_cvt_pk_bf16_f32 v76, v64, v65
    v_cvt_pk_bf16_f32 v77, v66, v67
    v_exp_f32 v70, v70
    v_exp_f32 v71, v71
    v_exp_f32 v40, v40
    v_exp_f32 v41, v41
    v_cvt_pk_bf16_f32 v78, v68, v69
    v_cvt_pk_bf16_f32 v79, v70, v71
    ds_read_b128 v[104:107], v6 offset:2048
    ds_read_b128 v[108:111], v6 offset:2560
    v_exp_f32 v42, v42
    v_exp_f32 v43, v43
    v_mfma_f32_32x32x16_bf16 v[80:95], v[116:119], v[76:79], v[80:95]
    v_exp_f32 v44, v44
    v_exp_f32 v45, v45
    v_cvt_pk_bf16_f32 v72, v40, v41
    v_cvt_pk_bf16_f32 v73, v42, v43
    s_waitcnt lgkmcnt(2)
    v_mfma_f32_32x32x16_bf16 v[56:71], v[100:103], v[20:23], v[24:39]
    ds_read_b128 v[96:99], v3 offset:57344
    v_exp_f32 v46, v46
    v_exp_f32 v47, v47
    v_exp_f32 v48, v48
    v_exp_f32 v49, v49
    v_cvt_pk_bf16_f32 v74, v44, v45
    v_cvt_pk_bf16_f32 v75, v46, v47
    v_exp_f32 v50, v50
    v_exp_f32 v51, v51
    s_waitcnt lgkmcnt(1)
    v_mfma_f32_32x32x16_bf16 v[80:95], v[104:107], v[72:75], v[80:95]
    v_exp_f32 v52, v52
    v_exp_f32 v53, v53
    v_cvt_pk_bf16_f32 v76, v48, v49
    v_cvt_pk_bf16_f32 v77, v50, v51
    v_exp_f32 v54, v54
    v_exp_f32 v55, v55
    v_exp_f32 v56, v56
    v_exp_f32 v57, v57
    v_cvt_pk_bf16_f32 v78, v52, v53
    v_cvt_pk_bf16_f32 v79, v54, v55
    ds_read_b128 v[112:115], v6 offset:3072
    ds_read_b128 v[116:119], v6 offset:3584
    v_exp_f32 v58, v58
    v_exp_f32 v59, v59
    v_mfma_f32_32x32x16_bf16 v[80:95], v[108:111], v[76:79], v[80:95]
    v_exp_f32 v60, v60
    v_exp_f32 v61, v61
    v_cvt_pk_bf16_f32 v72, v56, v57
    v_cvt_pk_bf16_f32 v73, v58, v59
    s_waitcnt lgkmcnt(2)
    v_mfma_f32_32x32x16_bf16 v[40:55], v[96:99], v[20:23], v[24:39]
    ds_read_b128 v[100:103], v3 offset:58368
    v_exp_f32 v62, v62
    v_exp_f32 v63, v63
    v_exp_f32 v64, v64
    v_exp_f32 v65, v65
    v_cvt_pk_bf16_f32 v74, v60, v61
    v_cvt_pk_bf16_f32 v75, v62, v63
    v_exp_f32 v66, v66
    v_exp_f32 v67, v67
    s_waitcnt lgkmcnt(1)
    v_mfma_f32_32x32x16_bf16 v[80:95], v[112:115], v[72:75], v[80:95]
    v_exp_f32 v68, v68
    v_exp_f32 v69, v69
    v_cvt_pk_bf16_f32 v76, v64, v65
    v_cvt_pk_bf16_f32 v77, v66, v67
    v_exp_f32 v70, v70
    v_exp_f32 v71, v71
    v_exp_f32 v40, v40
    v_exp_f32 v41, v41
    v_cvt_pk_bf16_f32 v78, v68, v69
    v_cvt_pk_bf16_f32 v79, v70, v71
    v_add_u32 v6, v6, v7
    ds_read_b128 v[104:107], v6 offset:0
    ds_read_b128 v[108:111], v6 offset:512
    v_exp_f32 v42, v42
    v_exp_f32 v43, v43
    v_mfma_f32_32x32x16_bf16 v[80:95], v[116:119], v[76:79], v[80:95]
    v_exp_f32 v44, v44
    v_exp_f32 v45, v45
    v_cvt_pk_bf16_f32 v72, v40, v41
    v_cvt_pk_bf16_f32 v73, v42, v43
    s_waitcnt lgkmcnt(2)
    v_mfma_f32_32x32x16_bf16 v[56:71], v[100:103], v[20:23], v[24:39]
    ds_read_b128 v[96:99], v3 offset:59392
    v_exp_f32 v46, v46
    v_exp_f32 v47, v47
    v_exp_f32 v48, v48
    v_exp_f32 v49, v49
    v_cvt_pk_bf16_f32 v74, v44, v45
    v_cvt_pk_bf16_f32 v75, v46, v47
    v_exp_f32 v50, v50
    v_exp_f32 v51, v51
    s_waitcnt lgkmcnt(1)
    v_mfma_f32_32x32x16_bf16 v[80:95], v[104:107], v[72:75], v[80:95]
    v_exp_f32 v52, v52
    v_exp_f32 v53, v53
    v_cvt_pk_bf16_f32 v76, v48, v49
    v_cvt_pk_bf16_f32 v77, v50, v51
    v_exp_f32 v54, v54
    v_exp_f32 v55, v55
    v_exp_f32 v56, v56
    v_exp_f32 v57, v57
    v_cvt_pk_bf16_f32 v78, v52, v53
    v_cvt_pk_bf16_f32 v79, v54, v55
    ds_read_b128 v[112:115], v6 offset:1024
    ds_read_b128 v[116:119], v6 offset:1536
    v_exp_f32 v58, v58
    v_exp_f32 v59, v59
    v_mfma_f32_32x32x16_bf16 v[80:95], v[108:111], v[76:79], v[80:95]
    v_exp_f32 v60, v60
    v_exp_f32 v61, v61
    v_cvt_pk_bf16_f32 v72, v56, v57
    v_cvt_pk_bf16_f32 v73, v58, v59
    s_waitcnt lgkmcnt(2)
    v_mfma_f32_32x32x16_bf16 v[40:55], v[96:99], v[20:23], v[24:39]
    ds_read_b128 v[100:103], v3 offset:60416
    v_exp_f32 v62, v62
    v_exp_f32 v63, v63
    v_exp_f32 v64, v64
    v_exp_f32 v65, v65
    v_cvt_pk_bf16_f32 v74, v60, v61
    v_cvt_pk_bf16_f32 v75, v62, v63
    v_exp_f32 v66, v66
    v_exp_f32 v67, v67
    s_waitcnt lgkmcnt(1)
    v_mfma_f32_32x32x16_bf16 v[80:95], v[112:115], v[72:75], v[80:95]
    v_exp_f32 v68, v68
    v_exp_f32 v69, v69
    v_cvt_pk_bf16_f32 v76, v64, v65
    v_cvt_pk_bf16_f32 v77, v66, v67
    v_exp_f32 v70, v70
    v_exp_f32 v71, v71
    v_exp_f32 v40, v40
    v_exp_f32 v41, v41
    v_cvt_pk_bf16_f32 v78, v68, v69
    v_cvt_pk_bf16_f32 v79, v70, v71
    ds_read_b128 v[104:107], v6 offset:2048
    ds_read_b128 v[108:111], v6 offset:2560
    v_exp_f32 v42, v42
    v_exp_f32 v43, v43
    v_mfma_f32_32x32x16_bf16 v[80:95], v[116:119], v[76:79], v[80:95]
    v_exp_f32 v44, v44
    v_exp_f32 v45, v45
    v_cvt_pk_bf16_f32 v72, v40, v41
    v_cvt_pk_bf16_f32 v73, v42, v43
    s_waitcnt lgkmcnt(2)
    v_mfma_f32_32x32x16_bf16 v[56:71], v[100:103], v[20:23], v[24:39]
    ds_read_b128 v[96:99], v3 offset:61440
    v_exp_f32 v46, v46
    v_exp_f32 v47, v47
    v_exp_f32 v48, v48
    v_exp_f32 v49, v49
    v_cvt_pk_bf16_f32 v74, v44, v45
    v_cvt_pk_bf16_f32 v75, v46, v47
    v_exp_f32 v50, v50
    v_exp_f32 v51, v51
    s_waitcnt lgkmcnt(1)
    v_mfma_f32_32x32x16_bf16 v[80:95], v[104:107], v[72:75], v[80:95]
    v_exp_f32 v52, v52
    v_exp_f32 v53, v53
    v_cvt_pk_bf16_f32 v76, v48, v49
    v_cvt_pk_bf16_f32 v77, v50, v51
    v_exp_f32 v54, v54
    v_exp_f32 v55, v55
    v_exp_f32 v56, v56
    v_exp_f32 v57, v57
    v_cvt_pk_bf16_f32 v78, v52, v53
    v_cvt_pk_bf16_f32 v79, v54, v55
    ds_read_b128 v[112:115], v6 offset:3072
    ds_read_b128 v[116:119], v6 offset:3584
    v_exp_f32 v58, v58
    v_exp_f32 v59, v59
    v_mfma_f32_32x32x16_bf16 v[80:95], v[108:111], v[76:79], v[80:95]
    v_exp_f32 v60, v60
    v_exp_f32 v61, v61
    v_cvt_pk_bf16_f32 v72, v56, v57
    v_cvt_pk_bf16_f32 v73, v58, v59
    s_waitcnt lgkmcnt(2)
    v_mfma_f32_32x32x16_bf16 v[40:55], v[96:99], v[20:23], v[24:39]
    ds_read_b128 v[100:103], v3 offset:62464
    v_exp_f32 v62, v62
    v_exp_f32 v63, v63
    v_exp_f32 v64, v64
    v_exp_f32 v65, v65
    v_cvt_pk_bf16_f32 v74, v60, v61
    v_cvt_pk_bf16_f32 v75, v62, v63
    v_exp_f32 v66, v66
    v_exp_f32 v67, v67
    s_waitcnt lgkmcnt(1)
    v_mfma_f32_32x32x16_bf16 v[80:95], v[112:115], v[72:75], v[80:95]
    v_exp_f32 v68, v68
    v_exp_f32 v69, v69
    v_cvt_pk_bf16_f32 v76, v64, v65
    v_cvt_pk_bf16_f32 v77, v66, v67
    v_exp_f32 v70, v70
    v_exp_f32 v71, v71
    v_exp_f32 v40, v40
    v_exp_f32 v41, v41
    v_cvt_pk_bf16_f32 v78, v68, v69
    v_cvt_pk_bf16_f32 v79, v70, v71
    v_add_u32 v6, v6, v7
    ds_read_b128 v[104:107], v6 offset:0
    ds_read_b128 v[108:111], v6 offset:512
    v_exp_f32 v42, v42
    v_exp_f32 v43, v43
    v_mfma_f32_32x32x16_bf16 v[80:95], v[116:119], v[76:79], v[80:95]
    s_setprio 0
    v_exp_f32 v44, v44
    v_exp_f32 v45, v45
    v_cvt_pk_bf16_f32 v72, v40, v41
    v_cvt_pk_bf16_f32 v73, v42, v43
    s_waitcnt lgkmcnt(2)
    v_mfma_f32_32x32x16_bf16 v[56:71], v[100:103], v[20:23], v[24:39]
    ds_read_b128 v[96:99], v3 offset:63488
    v_exp_f32 v46, v46
    v_exp_f32 v47, v47
    v_exp_f32 v48, v48
    v_exp_f32 v49, v49
    v_cvt_pk_bf16_f32 v74, v44, v45
    v_cvt_pk_bf16_f32 v75, v46, v47
    v_exp_f32 v50, v50
    v_exp_f32 v51, v51
    s_waitcnt lgkmcnt(1)
    v_mfma_f32_32x32x16_bf16 v[80:95], v[104:107], v[72:75], v[80:95]
    v_exp_f32 v52, v52
    v_exp_f32 v53, v53
    v_cvt_pk_bf16_f32 v76, v48, v49
    v_cvt_pk_bf16_f32 v77, v50, v51
    v_exp_f32 v54, v54
    v_exp_f32 v55, v55
    v_exp_f32 v56, v56
    v_exp_f32 v57, v57
    v_cvt_pk_bf16_f32 v78, v52, v53
    v_cvt_pk_bf16_f32 v79, v54, v55
    ds_read_b128 v[112:115], v6 offset:1024
    ds_read_b128 v[116:119], v6 offset:1536
    v_exp_f32 v58, v58
    v_exp_f32 v59, v59
    v_mfma_f32_32x32x16_bf16 v[80:95], v[108:111], v[76:79], v[80:95]
    v_exp_f32 v60, v60
    v_exp_f32 v61, v61
    v_cvt_pk_bf16_f32 v72, v56, v57
    v_cvt_pk_bf16_f32 v73, v58, v59
    s_waitcnt lgkmcnt(2)
    v_mfma_f32_32x32x16_bf16 v[40:55], v[96:99], v[20:23], v[24:39]
    ds_read_b128 v[100:103], v3 offset:64512
    v_exp_f32 v62, v62
    v_exp_f32 v63, v63
    v_exp_f32 v64, v64
    v_exp_f32 v65, v65
    v_cvt_pk_bf16_f32 v74, v60, v61
    v_cvt_pk_bf16_f32 v75, v62, v63
    v_exp_f32 v66, v66
    v_exp_f32 v67, v67
    s_waitcnt lgkmcnt(1)
    v_mfma_f32_32x32x16_bf16 v[80:95], v[112:115], v[72:75], v[80:95]
    v_exp_f32 v68, v68
    v_exp_f32 v69, v69
    v_cvt_pk_bf16_f32 v76, v64, v65
    v_cvt_pk_bf16_f32 v77, v66, v67
    v_exp_f32 v70, v70
    v_exp_f32 v71, v71
    v_exp_f32 v40, v40
    v_exp_f32 v41, v41
    v_cvt_pk_bf16_f32 v78, v68, v69
    v_cvt_pk_bf16_f32 v79, v70, v71
    ds_read_b128 v[104:107], v6 offset:2048
    ds_read_b128 v[108:111], v6 offset:2560
    v_exp_f32 v42, v42
    v_exp_f32 v43, v43
    v_mfma_f32_32x32x16_bf16 v[80:95], v[116:119], v[76:79], v[80:95]
    v_exp_f32 v44, v44
    v_exp_f32 v45, v45
    v_cvt_pk_bf16_f32 v72, v40, v41
    v_cvt_pk_bf16_f32 v73, v42, v43
    s_waitcnt lgkmcnt(2)
    v_mfma_f32_32x32x16_bf16 v[56:71], v[100:103], v[20:23], v[24:39]
    ds_read_b128 v[96:99], v3 offset:0
    v_exp_f32 v46, v46
    v_exp_f32 v47, v47
    v_exp_f32 v48, v48
    v_exp_f32 v49, v49
    v_cvt_pk_bf16_f32 v74, v44, v45
    v_cvt_pk_bf16_f32 v75, v46, v47
    v_exp_f32 v50, v50
    v_exp_f32 v51, v51
    s_waitcnt lgkmcnt(1)
    v_mfma_f32_32x32x16_bf16 v[80:95], v[104:107], v[72:75], v[80:95]
    v_exp_f32 v52, v52
    v_exp_f32 v53, v53
    v_cvt_pk_bf16_f32 v76, v48, v49
    v_cvt_pk_bf16_f32 v77, v50, v51
    v_exp_f32 v54, v54
    v_exp_f32 v55, v55
    v_exp_f32 v56, v56
    v_exp_f32 v57, v57
    v_cvt_pk_bf16_f32 v78, v52, v53
    v_cvt_pk_bf16_f32 v79, v54, v55
    ds_read_b128 v[112:115], v6 offset:3072
    ds_read_b128 v[116:119], v6 offset:3584
    v_exp_f32 v58, v58
    v_exp_f32 v59, v59
    v_mfma_f32_32x32x16_bf16 v[80:95], v[108:111], v[76:79], v[80:95]
    v_exp_f32 v60, v60
    v_exp_f32 v61, v61
    v_cvt_pk_bf16_f32 v72, v56, v57
    v_cvt_pk_bf16_f32 v73, v58, v59
    s_waitcnt lgkmcnt(2)
    v_mfma_f32_32x32x16_bf16 v[40:55], v[96:99], v[20:23], v[24:39]
    ds_read_b128 v[100:103], v3 offset:1024
    v_exp_f32 v62, v62
    v_exp_f32 v63, v63
    v_exp_f32 v64, v64
    v_exp_f32 v65, v65
    v_cvt_pk_bf16_f32 v74, v60, v61
    v_cvt_pk_bf16_f32 v75, v62, v63
    v_exp_f32 v66, v66
    v_exp_f32 v67, v67
    s_waitcnt lgkmcnt(1)
    v_mfma_f32_32x32x16_bf16 v[80:95], v[112:115], v[72:75], v[80:95]
    v_exp_f32 v68, v68
    v_exp_f32 v69, v69
    v_cvt_pk_bf16_f32 v76, v64, v65
    v_cvt_pk_bf16_f32 v77, v66, v67
    v_exp_f32 v70, v70
    v_exp_f32 v71, v71
    v_exp_f32 v40, v40
    v_exp_f32 v41, v41
    v_cvt_pk_bf16_f32 v78, v68, v69
    v_cvt_pk_bf16_f32 v79, v70, v71
    v_add_u32 v6, v6, v7
    ds_read_b128 v[104:107], v6 offset:0
    ds_read_b128 v[108:111], v6 offset:512
    v_exp_f32 v42, v42
    v_exp_f32 v43, v43
    v_mfma_f32_32x32x16_bf16 v[80:95], v[116:119], v[76:79], v[80:95]
    s_setprio 0
    s_waitcnt lgkmcnt(0)
    s_lshl_b32 s50, s49, 15
    s_lshl_b32 s51, s48, 10
    s_add_u32 s50, s50, s51
    s_add_u32 s50, s50, 6291456
    s_nop 5
    v_rcp_f32 v72, v88
    s_nop 0
    v_mul_f32 v80, v80, v72
    v_mul_f32 v81, v81, v72
    v_mul_f32 v82, v82, v72
    v_mul_f32 v83, v83, v72
    v_mul_f32 v84, v84, v72
    v_mul_f32 v85, v85, v72
    v_mul_f32 v86, v86, v72
    v_mul_f32 v87, v87, v72
    v_cvt_pk_bf16_f32 v96, v80, v81
    v_cvt_pk_bf16_f32 v97, v82, v83
    v_cvt_pk_bf16_f32 v98, v84, v85
    v_cvt_pk_bf16_f32 v99, v86, v87
    buffer_store_dwordx4 v[96:99], v2, s[8:11], s50 offen sc1
    s_lshr_b32 s7, s2, 5
    s_lshl_b32 s7, s7, 5
    s_and_b32 s45, s2, 7
    s_lshl_b32 s45, s45, 2
    s_add_u32 s7, s7, s45
    s_bfe_u32 s45, s2, 0x20003
    s_add_u32 s7, s7, s45
    s_lshl_b32 s7, s7, 2
    s_add_u32 s7, s7, 22938624
    v_mov_b32 v16, 1
    v_mov_b32 v17, 0
    s_waitcnt vmcnt(0)
    s_barrier
    s_cmp_lg_u32 s3, 1
    s_cbranch_scc1 L_sequential_preLN__softmax_full_mha__swiglu_ffn__prompt_nopub_32
    s_mov_b64 exec, 1
    buffer_store_dword v16, v17, s[8:11], s7 offen sc1
    s_mov_b64 exec, -1
L_sequential_preLN__softmax_full_mha__swiglu_ffn__prompt_nopub_32:
    s_and_b32 s48, s2, 7
    s_lshl_b32 s48, s48, 2
    s_bfe_u32 s50, s2, 0x20003
    s_add_u32 s48, s48, s50
    s_lshr_b32 s49, s2, 5
    s_lshr_b32 s52, s2, 3
    s_and_b32 s59, s52, 7
    s_lshl_b32 s59, s59, 2
    s_mov_b32 s59, 0
    s_mul_i32 s53, s52, 3
    s_and_b32 s54, s2, 7
    s_lshl_b32 s54, s54, 3
    s_add_u32 s54, s54, s3
    s_lshl_b32 s55, s54, 15
    s_add_u32 s55, s55, 8388608
    s_cmp_ge_u32 s3, 4
    s_cbranch_scc1 L_sequential_preLN__softmax_full_mha__swiglu_ffn__prompt_p3_loader_33
    s_and_b32 s60, s3, 1
    s_lshr_b32 s61, s3, 1
    s_lshl_b32 s62, s48, 1
    s_add_u32 s62, s62, s61
    s_lshl_b32 s63, s49, 1
    s_add_u32 s63, s63, s60
    s_lshl_b32 s50, s60, 15
    v_add_u32 v197, s50, v2
    s_lshl_b32 s50, s61, 15
    s_add_u32 s50, s50, 65536
    v_add_u32 v198, s50, v2
    v_mov_b32 v20, 0
    v_mov_b32 v21, 0
    v_mov_b32 v22, 0
    v_mov_b32 v23, 0
    v_mov_b32 v24, 0
    v_mov_b32 v25, 0
    v_mov_b32 v26, 0
    v_mov_b32 v27, 0
    v_mov_b32 v28, 0
    v_mov_b32 v29, 0
    v_mov_b32 v30, 0
    v_mov_b32 v31, 0
    v_mov_b32 v32, 0
    v_mov_b32 v33, 0
    v_mov_b32 v34, 0
    v_mov_b32 v35, 0
    v_and_b32 v96, 31, v1
    v_lshrrev_b32 v97, 5, v1
    v_bfe_u32 v98, v1, 1, 3
    v_lshlrev_b32 v99, 7, v96
    v_lshl_add_u32 v99, v97, 3, v99
    s_lshl_b32 s50, s61, 12
    s_add_u32 s50, s50, 131072
    v_add_u32 v99, s50, v99
    s_lshl_b32 s51, s60, 2
    v_xor_b32 v100, s51, v98
    v_xor_b32 v100, 0, v100
    v_lshl_add_u32 v120, v100, 4, v99
    v_xor_b32 v100, s51, v98
    v_xor_b32 v100, 1, v100
    v_lshl_add_u32 v121, v100, 4, v99
    v_xor_b32 v100, s51, v98
    v_xor_b32 v100, 2, v100
    v_lshl_add_u32 v122, v100, 4, v99
    v_xor_b32 v100, s51, v98
    v_xor_b32 v100, 3, v100
    v_lshl_add_u32 v123, v100, 4, v99
    v_mov_b32 v6, v2
    v_add_u32 v7, 65536, v2
    v_mov_b32 v148, 0
    v_mov_b32 v149, 0
    v_mov_b32 v150, 0
    v_mov_b32 v151, 0
    v_mov_b32 v152, 0
    v_mov_b32 v153, 0
    v_mov_b32 v154, 0
    v_mov_b32 v155, 0
    v_mov_b32 v156, 0
    v_mov_b32 v157, 0
    v_mov_b32 v158, 0
    v_mov_b32 v159, 0
    v_mov_b32 v160, 0
    v_mov_b32 v161, 0
    v_mov_b32 v162, 0
    v_mov_b32 v163, 0
    v_mov_b32 v164, 0
    v_mov_b32 v165, 0
    v_mov_b32 v166, 0
    v_mov_b32 v167, 0
    v_mov_b32 v168, 0
    v_mov_b32 v169, 0
    v_mov_b32 v170, 0
    v_mov_b32 v171, 0
    v_mov_b32 v172, 0
    v_mov_b32 v173, 0
    v_mov_b32 v174, 0
    v_mov_b32 v175, 0
    v_mov_b32 v176, 0
    v_mov_b32 v177, 0
    v_mov_b32 v178, 0
    v_mov_b32 v179, 0
    v_mov_b32 v180, 0
    v_mov_b32 v181, 0
    v_mov_b32 v182, 0
    v_mov_b32 v183, 0
    v_mov_b32 v184, 0
    v_mov_b32 v185, 0
    v_mov_b32 v186, 0
    v_mov_b32 v187, 0
    v_mov_b32 v188, 0
    v_mov_b32 v189, 0
    v_mov_b32 v190, 0
    v_mov_b32 v191, 0
    v_mov_b32 v192, 0
    v_mov_b32 v193, 0
    v_mov_b32 v194, 0
    v_mov_b32 v195, 0
    s_cmp_lg_u32 s3, 0
    s_cbranch_scc1 L_sequential_preLN__softmax_full_mha__swiglu_ffn__prompt_nopoll_35
    v_and_b32 v17, 31, v1
    v_lshlrev_b32 v17, 2, v17
    s_add_u32 s44, s6, 22938624
    s_mov_b32 s45, 0
L_sequential_preLN__softmax_full_mha__swiglu_ffn__prompt_spin_36:
    s_add_u32 s45, s45, 1
    s_cmp_gt_u32 s45, 1048576
    s_cbranch_scc1 L_sequential_preLN__softmax_full_mha__swiglu_ffn__prompt_spin_out_37
    buffer_load_dword v16, v17, s[8:11], s44 offen sc1
    s_waitcnt vmcnt(0)
    v_cmp_ne_u32 vcc, 1, v16
    s_cbranch_vccnz L_sequential_preLN__softmax_full_mha__swiglu_ffn__prompt_spin_36
L_sequential_preLN__softmax_full_mha__swiglu_ffn__prompt_spin_out_37:
L_sequential_preLN__softmax_full_mha__swiglu_ffn__prompt_nopoll_35:
    s_barrier
    s_barrier
    ds_read_b128 v[56:59], v197 offset:0
    ds_read_b128 v[72:75], v198 offset:0
    ds_read_b128 v[60:63], v197 offset:1024
    ds_read_b128 v[76:79], v198 offset:1024
    ds_read_b128 v[64:67], v197 offset:2048
    ds_read_b128 v[80:83], v198 offset:2048
    ds_read_b128 v[68:71], v197 offset:3072
    ds_read_b128 v[84:87], v198 offset:3072
    s_waitcnt lgkmcnt(6)
    v_mfma_f32_32x32x16_bf16 v[20:35], v[56:59], v[72:75], v[20:35]
    ds_read_b128 v[56:59], v197 offset:4096
    ds_read_b128 v[72:75], v198 offset:4096
    s_waitcnt lgkmcnt(6)
    v_mfma_f32_32x32x16_bf16 v[20:35], v[60:63], v[76:79], v[20:35]
    ds_read_b128 v[60:63], v197 offset:5120
    ds_read_b128 v[76:79], v198 offset:5120
    s_waitcnt lgkmcnt(6)
    v_mfma_f32_32x32x16_bf16 v[20:35], v[64:67], v[80:83], v[20:35]
    ds_read_b128 v[64:67], v197 offset:6144
    ds_read_b128 v[80:83], v198 offset:6144
    s_waitcnt lgkmcnt(6)
    v_mfma_f32_32x32x16_bf16 v[20:35], v[68:71], v[84:87], v[20:35]
    ds_read_b128 v[68:71], v197 offset:7168
    ds_read_b128 v[84:87], v198 offset:7168
    s_waitcnt lgkmcnt(6)
    v_mfma_f32_32x32x16_bf16 v[20:35], v[56:59], v[72:75], v[20:35]
    s_barrier
    ds_read_b128 v[56:59], v197 offset:8192
    ds_read_b128 v[72:75], v198 offset:8192
    s_waitcnt lgkmcnt(6)
    v_mfma_f32_32x32x16_bf16 v[20:35], v[60:63], v[76:79], v[20:35]
    ds_read_b128 v[60:63], v197 offset:9216
    ds_read_b128 v[76:79], v198 offset:9216
    s_waitcnt lgkmcnt(6)
    v_mfma_f32_32x32x16_bf16 v[20:35], v[64:67], v[80:83], v[20:35]
    ds_read_b128 v[64:67], v197 offset:10240
    ds_read_b128 v[80:83], v198 offset:10240
    s_waitcnt lgkmcnt(6)
    v_mfma_f32_32x32x16_bf16 v[20:35], v[68:71], v[84:87], v[20:35]
    ds_read_b128 v[68:71], v197 offset:11264
    ds_read_b128 v[84:87], v198 offset:11264
    s_waitcnt lgkmcnt(6)
    v_mfma_f32_32x32x16_bf16 v[20:35], v[56:59], v[72:75], v[20:35]
    ds_read_b128 v[56:59], v197 offset:12288
    ds_read_b128 v[72:75], v198 offset:12288
    s_waitcnt lgkmcnt(6)
    v_mfma_f32_32x32x16_bf16 v[20:35], v[60:63], v[76:79], v[20:35]
    ds_read_b128 v[60:63], v197 offset:13312
    ds_read_b128 v[76:79], v198 offset:13312
    s_waitcnt lgkmcnt(6)
    v_mfma_f32_32x32x16_bf16 v[20:35], v[64:67], v[80:83], v[20:35]
    ds_read_b128 v[64:67], v197 offset:14336
    ds_read_b128 v[80:83], v198 offset:14336
    s_waitcnt lgkmcnt(6)
    v_mfma_f32_32x32x16_bf16 v[20:35], v[68:71], v[84:87], v[20:35]
    ds_read_b128 v[68:71], v197 offset:15360
    ds_read_b128 v[84:87], v198 offset:15360
    s_waitcnt lgkmcnt(6)
    v_mfma_f32_32x32x16_bf16 v[20:35], v[56:59], v[72:75], v[20:35]
    s_barrier
    ds_read_b128 v[56:59], v197 offset:16384
    ds_read_b128 v[72:75], v198 offset:16384
    s_waitcnt lgkmcnt(6)
    v_mfma_f32_32x32x16_bf16 v[20:35], v[60:63], v[76:79], v[20:35]
    ds_read_b128 v[60:63], v197 offset:17408
    ds_read_b128 v[76:79], v198 offset:17408
    s_waitcnt lgkmcnt(6)
    v_mfma_f32_32x32x16_bf16 v[20:35], v[64:67], v[80:83], v[20:35]
    ds_read_b128 v[64:67], v197 offset:18432
    ds_read_b128 v[80:83], v198 offset:18432
    s_waitcnt lgkmcnt(6)
    v_mfma_f32_32x32x16_bf16 v[20:35], v[68:71], v[84:87], v[20:35]
    ds_read_b128 v[68:71], v197 offset:19456
    ds_read_b128 v[84:87], v198 offset:19456
    s_waitcnt lgkmcnt(6)
    v_mfma_f32_32x32x16_bf16 v[20:35], v[56:59], v[72:75], v[20:35]
    ds_read_b128 v[56:59], v197 offset:20480
    ds_read_b128 v[72:75], v198 offset:20480
    s_waitcnt lgkmcnt(6)
    v_mfma_f32_32x32x16_bf16 v[20:35], v[60:63], v[76:79], v[20:35]
    ds_read_b128 v[60:63], v197 offset:21504
    ds_read_b128 v[76:79], v198 offset:21504
    s_waitcnt lgkmcnt(6)
    v_mfma_f32_32x32x16_bf16 v[20:35], v[64:67], v[80:83], v[20:35]
    ds_read_b128 v[64:67], v197 offset:22528
    ds_read_b128 v[80:83], v198 offset:22528
    s_waitcnt lgkmcnt(6)
    v_mfma_f32_32x32x16_bf16 v[20:35], v[68:71], v[84:87], v[20:35]
    ds_read_b128 v[68:71], v197 offset:23552
    ds_read_b128 v[84:87], v198 offset:23552
    s_waitcnt lgkmcnt(6)
    v_mfma_f32_32x32x16_bf16 v[20:35], v[56:59], v[72:75], v[20:35]
    s_barrier
    ds_read_b128 v[56:59], v197 offset:24576
    ds_read_b128 v[72:75], v198 offset:24576
    s_waitcnt lgkmcnt(6)
    v_mfma_f32_32x32x16_bf16 v[20:35], v[60:63], v[76:79], v[20:35]
    ds_read_b128 v[60:63], v197 offset:25600
    ds_read_b128 v[76:79], v198 offset:25600
    s_waitcnt lgkmcnt(6)
    v_mfma_f32_32x32x16_bf16 v[20:35], v[64:67], v[80:83], v[20:35]
    ds_read_b128 v[64:67], v197 offset:26624
    ds_read_b128 v[80:83], v198 offset:26624
    s_waitcnt lgkmcnt(6)
    v_mfma_f32_32x32x16_bf16 v[20:35], v[68:71], v[84:87], v[20:35]
    ds_read_b128 v[68:71], v197 offset:27648
    ds_read_b128 v[84:87], v198 offset:27648
    s_waitcnt lgkmcnt(6)
    v_mfma_f32_32x32x16_bf16 v[20:35], v[56:59], v[72:75], v[20:35]
    ds_read_b128 v[56:59], v197 offset:28672
    ds_read_b128 v[72:75], v198 offset:28672
    s_waitcnt lgkmcnt(6)
    v_mfma_f32_32x32x16_bf16 v[20:35], v[60:63], v[76:79], v[20:35]
    ds_read_b128 v[60:63], v197 offset:29696
    ds_read_b128 v[76:79], v198 offset:29696
    s_waitcnt lgkmcnt(6)
    v_mfma_f32_32x32x16_bf16 v[20:35], v[64:67], v[80:83], v[20:35]
    ds_read_b128 v[64:67], v197 offset:30720
    ds_read_b128 v[80:83], v198 offset:30720
    s_waitcnt lgkmcnt(6)
    v_mfma_f32_32x32x16_bf16 v[20:35], v[68:71], v[84:87], v[20:35]
    ds_read_b128 v[68:71], v197 offset:31744
    ds_read_b128 v[84:87], v198 offset:31744
    s_waitcnt lgkmcnt(6)
    v_mfma_f32_32x32x16_bf16 v[20:35], v[56:59], v[72:75], v[20:35]
    s_waitcnt lgkmcnt(4)
    v_mfma_f32_32x32x16_bf16 v[20:35], v[60:63], v[76:79], v[20:35]
    s_waitcnt lgkmcnt(2)
    v_mfma_f32_32x32x16_bf16 v[20:35], v[64:67], v[80:83], v[20:35]
    s_waitcnt lgkmcnt(0)
    s_barrier
    v_mfma_f32_32x32x16_bf16 v[20:35], v[68:71], v[84:87], v[20:35]
    ds_read_b64 v[88:89], v120
    ds_read_b64 v[90:91], v121
    ds_read_b64 v[92:93], v122
    ds_read_b64 v[94:95], v123
    s_lshl_b32 s50, s62, 15
    s_lshl_b32 s51, s63, 11
    s_add_u32 s50, s50, s51
    s_add_u32 s50, s50, 8388608
    s_nop 3
    s_waitcnt lgkmcnt(0)
    v_lshlrev_b32 v96, 16, v88
    v_and_b32 v97, 0xffff0000, v88
    v_add_f32 v20, v20, v96
    v_add_f32 v21, v21, v97
    v_lshlrev_b32 v98, 16, v89
    v_and_b32 v99, 0xffff0000, v89
    v_add_f32 v22, v22, v98
    v_add_f32 v23, v23, v99
    v_lshlrev_b32 v96, 16, v90
    v_and_b32 v97, 0xffff0000, v90
    v_add_f32 v24, v24, v96
    v_add_f32 v25, v25, v97
    v_lshlrev_b32 v98, 16, v91
    v_and_b32 v99, 0xffff0000, v91
    v_add_f32 v26, v26, v98
    v_add_f32 v27, v27, v99
    v_lshlrev_b32 v96, 16, v92
    v_and_b32 v97, 0xffff0000, v92
    v_add_f32 v28, v28, v96
    v_add_f32 v29, v29, v97
    v_lshlrev_b32 v98, 16, v93
    v_and_b32 v99, 0xffff0000, v93
    v_add_f32 v30, v30, v98
    v_add_f32 v31, v31, v99
    v_lshlrev_b32 v96, 16, v94
    v_and_b32 v97, 0xffff0000, v94
    v_add_f32 v32, v32, v96
    v_add_f32 v33, v33, v97
    v_lshlrev_b32 v98, 16, v95
    v_and_b32 v99, 0xffff0000, v95
    v_add_f32 v34, v34, v98
    v_add_f32 v35, v35, v99
    v_cvt_pk_bf16_f32 v8, v20, v21
    v_cvt_pk_bf16_f32 v9, v22, v23
    v_cvt_pk_bf16_f32 v10, v24, v25
    v_cvt_pk_bf16_f32 v11, v26, v27
    v_cvt_pk_bf16_f32 v12, v28, v29
    v_cvt_pk_bf16_f32 v13, v30, v31
    v_cvt_pk_bf16_f32 v14, v32, v33
    v_cvt_pk_bf16_f32 v15, v34, v35
    s_cmp_eq_u32 s46, 1
    s_cbranch_scc1 L_sequential_preLN__softmax_full_mha__swiglu_ffn__prompt_st_fast_38
    buffer_store_dwordx4 v[8:11], v2, s[8:11], s50 offen offset:0 sc1
    buffer_store_dwordx4 v[12:15], v2, s[8:11], s50 offen offset:1024 sc1
    s_branch L_sequential_preLN__softmax_full_mha__swiglu_ffn__prompt_st_end_39
L_sequential_preLN__softmax_full_mha__swiglu_ffn__prompt_st_fast_38:
    buffer_store_dwordx4 v[8:11], v2, s[8:11], s50 offen offset:0
    buffer_store_dwordx4 v[12:15], v2, s[8:11], s50 offen offset:1024
L_sequential_preLN__softmax_full_mha__swiglu_ffn__prompt_st_end_39:
    v_add_f32 v96, v20, v21
    v_mul_f32 v97, v20, v20
    v_add_f32 v98, v22, v23
    v_mul_f32 v99, v21, v21
    v_fmac_f32 v97, v22, v22
    v_fmac_f32 v99, v23, v23
    v_add_f32 v96, v96, v24
    v_fmac_f32 v97, v24, v24
    v_add_f32 v98, v98, v25
    v_fmac_f32 v99, v25, v25
    v_add_f32 v96, v96, v26
    v_fmac_f32 v97, v26, v26
    v_add_f32 v98, v98, v27
    v_fmac_f32 v99, v27, v27
    v_add_f32 v96, v96, v28
    v_fmac_f32 v97, v28, v28
    v_add_f32 v98, v98, v29
    v_fmac_f32 v99, v29, v29
    v_add_f32 v96, v96, v30
    v_fmac_f32 v97, v30, v30
    v_add_f32 v98, v98, v31
    v_fmac_f32 v99, v31, v31
    v_add_f32 v96, v96, v32
    v_fmac_f32 v97, v32, v32
    v_add_f32 v98, v98, v33
    v_fmac_f32 v99, v33, v33
    v_add_f32 v96, v96, v34
    v_fmac_f32 v97, v34, v34
    v_add_f32 v98, v98, v35
    v_fmac_f32 v99, v35, v35
    v_add_f32 v96, v96, v98
    v_add_f32 v97, v97, v99
    s_lshl_b32 s50, s62, 12
    s_lshr_b32 s51, s63, 2
    s_lshl_b32 s51, s51, 10
    v_permlane32_swap_b32 v96, v97
    s_add_u32 s50, s50, s51
    s_and_b32 s51, s63, 3
    s_lshl_b32 s51, s51, 2
    s_add_u32 s50, s50, s51
    s_add_u32 s50, s50, 22282240
    v_add_f32 v96, v96, v97
    s_cmp_eq_u32 s46, 1
    s_cbranch_scc1 L_sequential_preLN__softmax_full_mha__swiglu_ffn__prompt_st_fast_40
    buffer_store_dword v96, v2, s[8:11], s50 offen sc1
    s_branch L_sequential_preLN__softmax_full_mha__swiglu_ffn__prompt_st_end_41
L_sequential_preLN__softmax_full_mha__swiglu_ffn__prompt_st_fast_40:
    buffer_store_dword v96, v2, s[8:11], s50 offen
L_sequential_preLN__softmax_full_mha__swiglu_ffn__prompt_st_end_41:
    s_lshr_b32 s7, s2, 3
    s_lshl_b32 s7, s7, 2
    s_add_u32 s7, s7, s6
    s_add_u32 s7, s7, 22939648
    v_mov_b32 v16, 1
    v_mov_b32 v17, 0
    s_waitcnt vmcnt(0)
    s_barrier
    s_cmp_lg_u32 s3, 1
    s_cbranch_scc1 L_sequential_preLN__softmax_full_mha__swiglu_ffn__prompt_nopub_42
    s_mov_b64 exec, 1
    s_cmp_eq_u32 s46, 1
    s_cbranch_scc1 L_sequential_preLN__softmax_full_mha__swiglu_ffn__prompt_st_fast_43
    buffer_store_dword v16, v17, s[8:11], s7 offen sc1
    s_branch L_sequential_preLN__softmax_full_mha__swiglu_ffn__prompt_st_end_44
L_sequential_preLN__softmax_full_mha__swiglu_ffn__prompt_st_fast_43:
    buffer_store_dword v16, v17, s[8:11], s7 offen
L_sequential_preLN__softmax_full_mha__swiglu_ffn__prompt_st_end_44:
    s_mov_b64 exec, -1
L_sequential_preLN__softmax_full_mha__swiglu_ffn__prompt_nopub_42:
    s_branch L_sequential_preLN__softmax_full_mha__swiglu_ffn__prompt_p3_done_34
L_sequential_preLN__softmax_full_mha__swiglu_ffn__prompt_p3_loader_33:
    s_and_b32 s64, s3, 1
    s_bfe_u32 s65, s3, 0x10001
    s_lshl_b32 s65, s65, 12
    s_lshl_b32 s62, s64, 15
    s_add_u32 s62, s62, s65
    s_add_u32 s63, s62, 65536
    s_lshl_b32 s60, s49, 16
    s_add_u32 s60, s60, s62
    s_add_u32 s60, s60, 16777216
    s_lshl_b32 s61, s48, 16
    s_add_u32 s61, s61, s62
    s_add_u32 s61, s61, 6291456
    s_add_u32 m0, s62, 0
    s_add_u32 s50, s60, 0
    buffer_load_dwordx4 v2, s[8:11], s50 offen offset:0 sc1 lds
    buffer_load_dwordx4 v2, s[8:11], s50 offen offset:1024 sc1 lds
    buffer_load_dwordx4 v2, s[8:11], s50 offen offset:2048 sc1 lds
    buffer_load_dwordx4 v2, s[8:11], s50 offen offset:3072 sc1 lds
    s_add_u32 m0, s62, 8192
    s_add_u32 s50, s60, 8192
    buffer_load_dwordx4 v2, s[8:11], s50 offen offset:0 sc1 lds
    buffer_load_dwordx4 v2, s[8:11], s50 offen offset:1024 sc1 lds
    buffer_load_dwordx4 v2, s[8:11], s50 offen offset:2048 sc1 lds
    buffer_load_dwordx4 v2, s[8:11], s50 offen offset:3072 sc1 lds
    s_add_u32 m0, s62, 16384
    s_add_u32 s50, s60, 16384
    buffer_load_dwordx4 v2, s[8:11], s50 offen offset:0 sc1 lds
    buffer_load_dwordx4 v2, s[8:11], s50 offen offset:1024 sc1 lds
    buffer_load_dwordx4 v2, s[8:11], s50 offen offset:2048 sc1 lds
    buffer_load_dwordx4 v2, s[8:11], s50 offen offset:3072 sc1 lds
    s_add_u32 m0, s62, 24576
    s_add_u32 s50, s60, 24576
    buffer_load_dwordx4 v2, s[8:11], s50 offen offset:0 sc1 lds
    buffer_load_dwordx4 v2, s[8:11], s50 offen offset:1024 sc1 lds
    buffer_load_dwordx4 v2, s[8:11], s50 offen offset:2048 sc1 lds
    buffer_load_dwordx4 v2, s[8:11], s50 offen offset:3072 sc1 lds
    v_lshrrev_b32 v197, 3, v1
    v_lshrrev_b32 v198, 4, v1
    v_or_b32 v198, 0, v198
    v_xor_b32 v198, v198, v1
    v_and_b32 v198, 7, v198
    v_lshlrev_b32 v197, 10, v197
    v_lshl_add_u32 v197, v198, 4, v197
    s_sub_u32 s50, s3, 4
    s_lshl_b32 s50, s50, 1
    s_add_u32 s50, s50, 0
    s_lshl_b32 s51, s50, 10
    s_add_u32 m0, s51, 131072
    s_lshl_b32 s50, s50, 13
    s_lshl_b32 s51, s48, 16
    s_add_u32 s50, s50, s51
    s_lshl_b32 s51, s49, 7
    s_add_u32 s50, s50, s51
    buffer_load_dwordx4 v197, s[12:15], s50 offen  lds
    v_lshrrev_b32 v197, 3, v1
    v_lshrrev_b32 v198, 4, v1
    v_or_b32 v198, 4, v198
    v_xor_b32 v198, v198, v1
    v_and_b32 v198, 7, v198
    v_lshlrev_b32 v197, 10, v197
    v_lshl_add_u32 v197, v198, 4, v197
    s_sub_u32 s50, s3, 4
    s_lshl_b32 s50, s50, 1
    s_add_u32 s50, s50, 1
    s_lshl_b32 s51, s50, 10
    s_add_u32 m0, s51, 131072
    s_lshl_b32 s50, s50, 13
    s_lshl_b32 s51, s48, 16
    s_add_u32 s50, s50, s51
    s_lshl_b32 s51, s49, 7
    s_add_u32 s50, s50, s51
    buffer_load_dwordx4 v197, s[12:15], s50 offen  lds
    s_sub_u32 s50, s3, 4
    s_min_u32 s50, s50, 2
    s_add_u32 s50, s50, s53
    s_min_u32 s50, s50, 87
    s_lshl_b32 s50, s50, 11
    s_add_u32 s50, s50, 22544384
    buffer_load_dwordx4 v[136:139], v2, s[8:11], s50 offen offset:0 sc1
    buffer_load_dwordx4 v[140:143], v2, s[8:11], s50 offen offset:1024 sc1
    v_mov_b32 v6, v2
    v_add_u32 v7, 65536, v2
    v_mov_b32 v148, 0
    v_mov_b32 v149, 0
    v_mov_b32 v150, 0
    v_mov_b32 v151, 0
    v_mov_b32 v152, 0
    v_mov_b32 v153, 0
    v_mov_b32 v154, 0
    v_mov_b32 v155, 0
    v_mov_b32 v156, 0
    v_mov_b32 v157, 0
    v_mov_b32 v158, 0
    v_mov_b32 v159, 0
    v_mov_b32 v160, 0
    v_mov_b32 v161, 0
    v_mov_b32 v162, 0
    v_mov_b32 v163, 0
    v_mov_b32 v164, 0
    v_mov_b32 v165, 0
    v_mov_b32 v166, 0
    v_mov_b32 v167, 0
    v_mov_b32 v168, 0
    v_mov_b32 v169, 0
    v_mov_b32 v170, 0
    v_mov_b32 v171, 0
    v_mov_b32 v172, 0
    v_mov_b32 v173, 0
    v_mov_b32 v174, 0
    v_mov_b32 v175, 0
    v_mov_b32 v176, 0
    v_mov_b32 v177, 0
    v_mov_b32 v178, 0
    v_mov_b32 v179, 0
    v_mov_b32 v180, 0
    v_mov_b32 v181, 0
    v_mov_b32 v182, 0
    v_mov_b32 v183, 0
    v_mov_b32 v184, 0
    v_mov_b32 v185, 0
    v_mov_b32 v186, 0
    v_mov_b32 v187, 0
    v_mov_b32 v188, 0
    v_mov_b32 v189, 0
    v_mov_b32 v190, 0
    v_mov_b32 v191, 0
    v_mov_b32 v192, 0
    v_mov_b32 v193, 0
    v_mov_b32 v194, 0
    v_mov_b32 v195, 0
    s_barrier
    s_add_u32 m0, s63, 0
    s_add_u32 s50, s61, 0
    buffer_load_dwordx4 v2, s[8:11], s50 offen offset:0 sc1 lds
    buffer_load_dwordx4 v2, s[8:11], s50 offen offset:1024 sc1 lds
    buffer_load_dwordx4 v2, s[8:11], s50 offen offset:2048 sc1 lds
    buffer_load_dwordx4 v2, s[8:11], s50 offen offset:3072 sc1 lds
    s_add_u32 m0, s63, 8192
    s_add_u32 s50, s61, 8192
    buffer_load_dwordx4 v2, s[8:11], s50 offen offset:0 sc1 lds
    buffer_load_dwordx4 v2, s[8:11], s50 offen offset:1024 sc1 lds
    buffer_load_dwordx4 v2, s[8:11], s50 offen offset:2048 sc1 lds
    buffer_load_dwordx4 v2, s[8:11], s50 offen offset:3072 sc1 lds
    s_add_u32 m0, s63, 16384
    s_add_u32 s50, s61, 16384
    buffer_load_dwordx4 v2, s[8:11], s50 offen offset:0 sc1 lds
    buffer_load_dwordx4 v2, s[8:11], s50 offen offset:1024 sc1 lds
    buffer_load_dwordx4 v2, s[8:11], s50 offen offset:2048 sc1 lds
    buffer_load_dwordx4 v2, s[8:11], s50 offen offset:3072 sc1 lds
    s_add_u32 m0, s63, 24576
    s_add_u32 s50, s61, 24576
    buffer_load_dwordx4 v2, s[8:11], s50 offen offset:0 sc1 lds
    buffer_load_dwordx4 v2, s[8:11], s50 offen offset:1024 sc1 lds
    buffer_load_dwordx4 v2, s[8:11], s50 offen offset:2048 sc1 lds
    buffer_load_dwordx4 v2, s[8:11], s50 offen offset:3072 sc1 lds
    s_waitcnt vmcnt(12)
    s_barrier
    s_waitcnt vmcnt(8)
    s_barrier
    s_waitcnt vmcnt(4)
    s_barrier
    v_add_f32 v136, v136, v140
    v_add_f32 v137, v137, v141
    v_add_f32 v138, v138, v142
    v_add_f32 v139, v139, v143
    s_waitcnt vmcnt(0)
    s_barrier
    v_add_f32_dpp v136, v136, v136 row_ror:8 row_mask:0xf bank_mask:0xf
    v_add_f32_dpp v137, v137, v137 row_ror:8 row_mask:0xf bank_mask:0xf
    v_add_f32_dpp v138, v138, v138 row_ror:8 row_mask:0xf bank_mask:0xf
    v_add_f32_dpp v139, v139, v139 row_ror:8 row_mask:0xf bank_mask:0xf
    v_mov_b32 v140, v136
    v_mov_b32 v141, v137
    v_mov_b32 v142, v138
    v_mov_b32 v143, v139
    s_nop 0
    v_permlane16_swap_b32 v136, v140
    v_permlane16_swap_b32 v137, v141
    v_permlane16_swap_b32 v138, v142
    v_permlane16_swap_b32 v139, v143
    v_add_f32 v136, v136, v140
    v_add_f32 v137, v137, v141
    v_add_f32 v138, v138, v142
    v_add_f32 v139, v139, v143
    v_mov_b32 v140, v136
    v_mov_b32 v141, v137
    v_mov_b32 v142, v138
    v_mov_b32 v143, v139
    s_nop 0
    v_permlane32_swap_b32 v136, v140
    v_permlane32_swap_b32 v137, v141
    v_permlane32_swap_b32 v138, v142
    v_permlane32_swap_b32 v139, v143
    v_add_f32 v136, v136, v140
    v_add_f32 v137, v137, v141
    v_add_f32 v138, v138, v142
    v_add_f32 v139, v139, v143
    v_cvt_pk_bf16_f32 v141, v136, v136
    v_and_b32 v142, 0xffff0000, v141
    v_sub_f32 v142, v136, v142
    v_cvt_pk_bf16_f32 v120, v136, v142
    v_and_b32 v121, 0xffff, v141
    v_mov_b32 v122, 0
    v_mov_b32 v123, 0
    v_cvt_pk_bf16_f32 v141, v137, v137
    v_and_b32 v142, 0xffff0000, v141
    v_sub_f32 v142, v137, v142
    v_cvt_pk_bf16_f32 v124, v137, v142
    v_and_b32 v125, 0xffff, v141
    v_mov_b32 v126, 0
    v_mov_b32 v127, 0
    v_cvt_pk_bf16_f32 v141, v138, v138
    v_and_b32 v142, 0xffff0000, v141
    v_sub_f32 v142, v138, v142
    v_cvt_pk_bf16_f32 v128, v138, v142
    v_and_b32 v129, 0xffff, v141
    v_mov_b32 v130, 0
    v_mov_b32 v131, 0
    v_cvt_pk_bf16_f32 v141, v139, v139
    v_and_b32 v142, 0xffff0000, v141
    v_sub_f32 v142, v139, v142
    v_cvt_pk_bf16_f32 v132, v139, v142
    v_and_b32 v133, 0xffff, v141
    v_mov_b32 v134, 0
    v_mov_b32 v135, 0
    v_mov_b32 v204, 0
    v_mov_b32 v205, 0
    v_mov_b32 v206, 0
    v_mov_b32 v207, 0
    s_sub_u32 s50, s3, 4
    s_min_u32 s50, s50, 2
    s_mul_i32 s50, s50, 33792
    s_add_u32 s50, s50, 32768
    v_and_b32 v140, 7, v1
    v_lshlrev_b32 v140, 6, v140
    v_add_u32 v140, s50, v140
    v_and_b32 v141, 31, v1
    v_lshlrev_b32 v141, 4, v141
    v_add_u32 v141, s50, v141
    s_sub_u32 s56, s3, 4
    s_mul_i32 s56, s56, 12
    s_barrier
    s_cmp_ge_u32 s52, 29
    s_cbranch_scc1 L_sequential_preLN__softmax_full_mha__swiglu_ffn__prompt_p4_noW_45
    ds_write_b128 v140, v[120:123] offset:0
    ds_write_b128 v140, v[124:127] offset:16
    ds_write_b128 v140, v[128:131] offset:32
    ds_write_b128 v140, v[132:135] offset:48
    ds_write_b128 v141, v[204:207] offset:512
    s_add_u32 s57, s56, 0
    s_lshr_b32 s58, s57, 4
    s_and_b32 s57, s57, 15
    s_add_u32 s57, s57, 0
    s_mul_i32 s51, s58, 33
    s_add_u32 s51, s51, s57
    s_lshl_b32 m0, s51, 10
    s_add_u32 s57, s57, s59
    s_and_b32 s57, s57, 31
    s_add_u32 s58, s58, s53
    s_lshl_b32 s58, s58, 5
    s_add_u32 s57, s57, s58
    s_lshl_b32 s57, s57, 10
    s_add_u32 s57, s57, 18874368
    buffer_load_dwordx4 v2, s[8:11], s57 offen offset:0 sc1 lds
    buffer_load_dwordx4 v2, s[8:11], s57 offen offset:1024 sc1 lds
    buffer_load_dwordx4 v2, s[8:11], s57 offen offset:2048 sc1 lds
    buffer_load_dwordx4 v2, s[8:11], s57 offen offset:3072 sc1 lds
    s_add_u32 s57, s56, 4
    s_lshr_b32 s58, s57, 4
    s_and_b32 s57, s57, 15
    s_add_u32 s57, s57, 0
    s_mul_i32 s51, s58, 33
    s_add_u32 s51, s51, s57
    s_lshl_b32 m0, s51, 10
    s_add_u32 s57, s57, s59
    s_and_b32 s57, s57, 31
    s_add_u32 s58, s58, s53
    s_lshl_b32 s58, s58, 5
    s_add_u32 s57, s57, s58
    s_lshl_b32 s57, s57, 10
    s_add_u32 s57, s57, 18874368
    buffer_load_dwordx4 v2, s[8:11], s57 offen offset:0 sc1 lds
    buffer_load_dwordx4 v2, s[8:11], s57 offen offset:1024 sc1 lds
    buffer_load_dwordx4 v2, s[8:11], s57 offen offset:2048 sc1 lds
    buffer_load_dwordx4 v2, s[8:11], s57 offen offset:3072 sc1 lds
    s_add_u32 s57, s56, 8
    s_lshr_b32 s58, s57, 4
    s_and_b32 s57, s57, 15
    s_add_u32 s57, s57, 0
    s_mul_i32 s51, s58, 33
    s_add_u32 s51, s51, s57
    s_lshl_b32 m0, s51, 10
    s_add_u32 s57, s57, s59
    s_and_b32 s57, s57, 31
    s_add_u32 s58, s58, s53
    s_lshl_b32 s58, s58, 5
    s_add_u32 s57, s57, s58
    s_lshl_b32 s57, s57, 10
    s_add_u32 s57, s57, 18874368
    buffer_load_dwordx4 v2, s[8:11], s57 offen offset:0 sc1 lds
    buffer_load_dwordx4 v2, s[8:11], s57 offen offset:1024 sc1 lds
    buffer_load_dwordx4 v2, s[8:11], s57 offen offset:2048 sc1 lds
    buffer_load_dwordx4 v2, s[8:11], s57 offen offset:3072 sc1 lds
L_sequential_preLN__softmax_full_mha__swiglu_ffn__prompt_p4_noW_45:
    s_barrier
L_sequential_preLN__softmax_full_mha__swiglu_ffn__prompt_p3_done_34:
    s_cmp_ge_u32 s52, 29
    s_cbranch_scc1 L_sequential_preLN__softmax_full_mha__swiglu_ffn__prompt_p4_idle_46
    s_cmp_lg_u32 s3, 0
    s_cbranch_scc1 L_sequential_preLN__softmax_full_mha__swiglu_ffn__prompt_nopoll_47
    v_and_b32 v17, 31, v1
    v_lshlrev_b32 v17, 2, v17
    s_add_u32 s44, s6, 22939648
    s_mov_b32 s45, 0
L_sequential_preLN__softmax_full_mha__swiglu_ffn__prompt_spin_48:
    s_add_u32 s45, s45, 1
    s_cmp_gt_u32 s45, 1048576
    s_cbranch_scc1 L_sequential_preLN__softmax_full_mha__swiglu_ffn__prompt_spin_out_49
    buffer_load_dword v16, v17, s[8:11], s44 offen sc1
    s_waitcnt vmcnt(0)
    v_cmp_ne_u32 vcc, 1, v16
    s_cbranch_vccnz L_sequential_preLN__softmax_full_mha__swiglu_ffn__prompt_spin_48
L_sequential_preLN__softmax_full_mha__swiglu_ffn__prompt_spin_out_49:
L_sequential_preLN__softmax_full_mha__swiglu_ffn__prompt_nopoll_47:
    s_waitcnt vmcnt(0) lgkmcnt(0)
    s_barrier
    s_add_u32 s51, s59, 0
    s_and_b32 s51, s51, 31
    s_lshl_b32 s51, s51, 10
    s_add_u32 s51, s51, s55
    buffer_load_dwordx4 v[56:59], v2, s[8:11], s51 offen offset:0 sc1
    s_add_u32 s51, s59, 0
    s_and_b32 s51, s51, 31
    s_lshl_b32 s51, s51, 10
    s_add_u32 s51, s51, s55
    buffer_load_dwordx4 v[60:63], v2, s[8:11], s51 offen offset:1024 sc1
    s_add_u32 s51, s59, 0
    s_and_b32 s51, s51, 31
    s_lshl_b32 s51, s51, 10
    s_add_u32 s51, s51, s55
    buffer_load_dwordx4 v[64:67], v2, s[8:11], s51 offen offset:2048 sc1
    s_add_u32 s51, s59, 0
    s_and_b32 s51, s51, 31
    s_lshl_b32 s51, s51, 10
    s_add_u32 s51, s51, s55
    buffer_load_dwordx4 v[68:71], v2, s[8:11], s51 offen offset:3072 sc1
    s_add_u32 s51, s59, 4
    s_and_b32 s51, s51, 31
    s_lshl_b32 s51, s51, 10
    s_add_u32 s51, s51, s55
    buffer_load_dwordx4 v[72:75], v2, s[8:11], s51 offen offset:0 sc1
    ds_read_b128 v[20:23], v6 offset:0
    ds_read_b128 v[24:27], v6 offset:33792
    ds_read_b128 v[28:31], v7 offset:2048
    ds_read_b128 v[32:35], v6 offset:1024
    ds_read_b128 v[36:39], v6 offset:34816
    ds_read_b128 v[40:43], v7 offset:3072
    s_add_u32 s51, s59, 4
    s_and_b32 s51, s51, 31
    s_lshl_b32 s51, s51, 10
    s_add_u32 s51, s51, s55
    buffer_load_dwordx4 v[76:79], v2, s[8:11], s51 offen offset:1024 sc1
    s_mul_i32 s57, s3, 6
    s_add_u32 s57, s57, 0
    s_lshr_b32 s58, s57, 4
    s_and_b32 s57, s57, 15
    s_add_u32 s57, s57, 16
    s_mul_i32 s50, s58, 33
    s_add_u32 s50, s50, s57
    s_lshl_b32 m0, s50, 10
    s_add_u32 s57, s57, s59
    s_and_b32 s57, s57, 31
    s_add_u32 s58, s58, s53
    s_lshl_b32 s58, s58, 5
    s_add_u32 s57, s57, s58
    s_lshl_b32 s57, s57, 10
    s_add_u32 s57, s57, 18874368
    buffer_load_dwordx4 v2, s[8:11], s57 offen sc1 lds
    s_waitcnt vmcnt(6) lgkmcnt(3)
    v_mfma_f32_32x32x16_bf16 v[148:163], v[20:23], v[56:59], v[148:163]
    ds_read_b128 v[44:47], v6 offset:2048
    v_mfma_f32_32x32x16_bf16 v[164:179], v[24:27], v[56:59], v[164:179]
    ds_read_b128 v[48:51], v6 offset:35840
    v_mfma_f32_32x32x16_bf16 v[180:195], v[28:31], v[56:59], v[180:195]
    ds_read_b128 v[52:55], v7 offset:4096
    s_add_u32 s51, s59, 4
    s_and_b32 s51, s51, 31
    s_lshl_b32 s51, s51, 10
    s_add_u32 s51, s51, s55
    buffer_load_dwordx4 v[80:83], v2, s[8:11], s51 offen offset:2048 sc1
    s_waitcnt vmcnt(6) lgkmcnt(3)
    v_mfma_f32_32x32x16_bf16 v[148:163], v[32:35], v[60:63], v[148:163]
    ds_read_b128 v[20:23], v6 offset:3072
    v_mfma_f32_32x32x16_bf16 v[164:179], v[36:39], v[60:63], v[164:179]
    ds_read_b128 v[24:27], v6 offset:36864
    v_mfma_f32_32x32x16_bf16 v[180:195], v[40:43], v[60:63], v[180:195]
    ds_read_b128 v[28:31], v7 offset:5120
    s_add_u32 s51, s59, 4
    s_and_b32 s51, s51, 31
    s_lshl_b32 s51, s51, 10
    s_add_u32 s51, s51, s55
    buffer_load_dwordx4 v[84:87], v2, s[8:11], s51 offen offset:3072 sc1
    s_mul_i32 s57, s3, 6
    s_add_u32 s57, s57, 1
    s_lshr_b32 s58, s57, 4
    s_and_b32 s57, s57, 15
    s_add_u32 s57, s57, 16
    s_mul_i32 s50, s58, 33
    s_add_u32 s50, s50, s57
    s_lshl_b32 m0, s50, 10
    s_add_u32 s57, s57, s59
    s_and_b32 s57, s57, 31
    s_add_u32 s58, s58, s53
    s_lshl_b32 s58, s58, 5
    s_add_u32 s57, s57, s58
    s_lshl_b32 s57, s57, 10
    s_add_u32 s57, s57, 18874368
    buffer_load_dwordx4 v2, s[8:11], s57 offen sc1 lds
    s_waitcnt vmcnt(7) lgkmcnt(3)
    v_mfma_f32_32x32x16_bf16 v[148:163], v[44:47], v[64:67], v[148:163]
    ds_read_b128 v[32:35], v6 offset:4096
    v_mfma_f32_32x32x16_bf16 v[164:179], v[48:51], v[64:67], v[164:179]
    ds_read_b128 v[36:39], v6 offset:37888
    v_mfma_f32_32x32x16_bf16 v[180:195], v[52:55], v[64:67], v[180:195]
    ds_read_b128 v[40:43], v7 offset:6144
    s_add_u32 s51, s59, 8
    s_and_b32 s51, s51, 31
    s_lshl_b32 s51, s51, 10
    s_add_u32 s51, s51, s55
    buffer_load_dwordx4 v[88:91], v2, s[8:11], s51 offen offset:0 sc1
    s_waitcnt vmcnt(7) lgkmcnt(3)
    v_mfma_f32_32x32x16_bf16 v[148:163], v[20:23], v[68:71], v[148:163]
    ds_read_b128 v[44:47], v6 offset:5120
    v_mfma_f32_32x32x16_bf16 v[164:179], v[24:27], v[68:71], v[164:179]
    ds_read_b128 v[48:51], v6 offset:38912
    v_mfma_f32_32x32x16_bf16 v[180:195], v[28:31], v[68:71], v[180:195]
    ds_read_b128 v[52:55], v7 offset:7168
    s_add_u32 s51, s59, 8
    s_and_b32 s51, s51, 31
    s_lshl_b32 s51, s51, 10
    s_add_u32 s51, s51, s55
    buffer_load_dwordx4 v[92:95], v2, s[8:11], s51 offen offset:1024 sc1
    s_mul_i32 s57, s3, 6
    s_add_u32 s57, s57, 2
    s_lshr_b32 s58, s57, 4
    s_and_b32 s57, s57, 15
    s_add_u32 s57, s57, 16
    s_mul_i32 s50, s58, 33
    s_add_u32 s50, s50, s57
    s_lshl_b32 m0, s50, 10
    s_add_u32 s57, s57, s59
    s_and_b32 s57, s57, 31
    s_add_u32 s58, s58, s53
    s_lshl_b32 s58, s58, 5
    s_add_u32 s57, s57, s58
    s_lshl_b32 s57, s57, 10
    s_add_u32 s57, s57, 18874368
    buffer_load_dwordx4 v2, s[8:11], s57 offen sc1 lds
    s_waitcnt vmcnt(8) lgkmcnt(3)
    v_mfma_f32_32x32x16_bf16 v[148:163], v[32:35], v[72:75], v[148:163]
    ds_read_b128 v[20:23], v6 offset:6144
    v_mfma_f32_32x32x16_bf16 v[164:179], v[36:39], v[72:75], v[164:179]
    ds_read_b128 v[24:27], v6 offset:39936
    v_mfma_f32_32x32x16_bf16 v[180:195], v[40:43], v[72:75], v[180:195]
    ds_read_b128 v[28:31], v7 offset:8192
    s_add_u32 s51, s59, 8
    s_and_b32 s51, s51, 31
    s_lshl_b32 s51, s51, 10
    s_add_u32 s51, s51, s55
    buffer_load_dwordx4 v[96:99], v2, s[8:11], s51 offen offset:2048 sc1
    s_waitcnt vmcnt(8) lgkmcnt(3)
    v_mfma_f32_32x32x16_bf16 v[148:163], v[44:47], v[76:79], v[148:163]
    ds_read_b128 v[32:35], v6 offset:7168
    v_mfma_f32_32x32x16_bf16 v[164:179], v[48:51], v[76:79], v[164:179]
    ds_read_b128 v[36:39], v6 offset:40960
    v_mfma_f32_32x32x16_bf16 v[180:195], v[52:55], v[76:79], v[180:195]
    ds_read_b128 v[40:43], v7 offset:9216
    s_add_u32 s51, s59, 8
    s_and_b32 s51, s51, 31
    s_lshl_b32 s51, s51, 10
    s_add_u32 s51, s51, s55
    buffer_load_dwordx4 v[100:103], v2, s[8:11], s51 offen offset:3072 sc1
    s_mul_i32 s57, s3, 6
    s_add_u32 s57, s57, 3
    s_lshr_b32 s58, s57, 4
    s_and_b32 s57, s57, 15
    s_add_u32 s57, s57, 16
    s_mul_i32 s50, s58, 33
    s_add_u32 s50, s50, s57
    s_lshl_b32 m0, s50, 10
    s_add_u32 s57, s57, s59
    s_and_b32 s57, s57, 31
    s_add_u32 s58, s58, s53
    s_lshl_b32 s58, s58, 5
    s_add_u32 s57, s57, s58
    s_lshl_b32 s57, s57, 10
    s_add_u32 s57, s57, 18874368
    buffer_load_dwordx4 v2, s[8:11], s57 offen sc1 lds
    s_waitcnt vmcnt(8) lgkmcnt(3)
    v_mfma_f32_32x32x16_bf16 v[148:163], v[20:23], v[80:83], v[148:163]
    ds_read_b128 v[44:47], v6 offset:8192
    v_mfma_f32_32x32x16_bf16 v[164:179], v[24:27], v[80:83], v[164:179]
    ds_read_b128 v[48:51], v6 offset:41984
    v_mfma_f32_32x32x16_bf16 v[180:195], v[28:31], v[80:83], v[180:195]
    ds_read_b128 v[52:55], v7 offset:10240
    s_add_u32 s51, s59, 12
    s_and_b32 s51, s51, 31
    s_lshl_b32 s51, s51, 10
    s_add_u32 s51, s51, s55
    buffer_load_dwordx4 v[104:107], v2, s[8:11], s51 offen offset:0 sc1
    s_waitcnt vmcnt(8) lgkmcnt(3)
    v_mfma_f32_32x32x16_bf16 v[148:163], v[32:35], v[84:87], v[148:163]
    ds_read_b128 v[20:23], v6 offset:9216
    v_mfma_f32_32x32x16_bf16 v[164:179], v[36:39], v[84:87], v[164:179]
    ds_read_b128 v[24:27], v6 offset:43008
    v_mfma_f32_32x32x16_bf16 v[180:195], v[40:43], v[84:87], v[180:195]
    ds_read_b128 v[28:31], v7 offset:11264
    s_add_u32 s51, s59, 12
    s_and_b32 s51, s51, 31
    s_lshl_b32 s51, s51, 10
    s_add_u32 s51, s51, s55
    buffer_load_dwordx4 v[108:111], v2, s[8:11], s51 offen offset:1024 sc1
    s_mul_i32 s57, s3, 6
    s_add_u32 s57, s57, 4
    s_lshr_b32 s58, s57, 4
    s_and_b32 s57, s57, 15
    s_add_u32 s57, s57, 16
    s_mul_i32 s50, s58, 33
    s_add_u32 s50, s50, s57
    s_lshl_b32 m0, s50, 10
    s_add_u32 s57, s57, s59
    s_and_b32 s57, s57, 31
    s_add_u32 s58, s58, s53
    s_lshl_b32 s58, s58, 5
    s_add_u32 s57, s57, s58
    s_lshl_b32 s57, s57, 10
    s_add_u32 s57, s57, 18874368
    buffer_load_dwordx4 v2, s[8:11], s57 offen sc1 lds
    s_waitcnt vmcnt(8) lgkmcnt(3)
    v_mfma_f32_32x32x16_bf16 v[148:163], v[44:47], v[88:91], v[148:163]
    ds_read_b128 v[32:35], v6 offset:10240
    v_mfma_f32_32x32x16_bf16 v[164:179], v[48:51], v[88:91], v[164:179]
    ds_read_b128 v[36:39], v6 offset:44032
    v_mfma_f32_32x32x16_bf16 v[180:195], v[52:55], v[88:91], v[180:195]
    ds_read_b128 v[40:43], v7 offset:12288
    s_add_u32 s51, s59, 12
    s_and_b32 s51, s51, 31
    s_lshl_b32 s51, s51, 10
    s_add_u32 s51, s51, s55
    buffer_load_dwordx4 v[112:115], v2, s[8:11], s51 offen offset:2048 sc1
    s_waitcnt vmcnt(8) lgkmcnt(3)
    v_mfma_f32_32x32x16_bf16 v[148:163], v[20:23], v[92:95], v[148:163]
    ds_read_b128 v[44:47], v6 offset:11264
    v_mfma_f32_32x32x16_bf16 v[164:179], v[24:27], v[92:95], v[164:179]
    ds_read_b128 v[48:51], v6 offset:45056
    v_mfma_f32_32x32x16_bf16 v[180:195], v[28:31], v[92:95], v[180:195]
    ds_read_b128 v[52:55], v7 offset:13312
    s_add_u32 s51, s59, 12
    s_and_b32 s51, s51, 31
    s_lshl_b32 s51, s51, 10
    s_add_u32 s51, s51, s55
    buffer_load_dwordx4 v[116:119], v2, s[8:11], s51 offen offset:3072 sc1
    s_mul_i32 s57, s3, 6
    s_add_u32 s57, s57, 5
    s_lshr_b32 s58, s57, 4
    s_and_b32 s57, s57, 15
    s_add_u32 s57, s57, 16
    s_mul_i32 s50, s58, 33
    s_add_u32 s50, s50, s57
    s_lshl_b32 m0, s50, 10
    s_add_u32 s57, s57, s59
    s_and_b32 s57, s57, 31
    s_add_u32 s58, s58, s53
    s_lshl_b32 s58, s58, 5
    s_add_u32 s57, s57, s58
    s_lshl_b32 s57, s57, 10
    s_add_u32 s57, s57, 18874368
    buffer_load_dwordx4 v2, s[8:11], s57 offen sc1 lds
    s_waitcnt vmcnt(8) lgkmcnt(3)
    v_mfma_f32_32x32x16_bf16 v[148:163], v[32:35], v[96:99], v[148:163]
    ds_read_b128 v[20:23], v6 offset:12288
    v_mfma_f32_32x32x16_bf16 v[164:179], v[36:39], v[96:99], v[164:179]
    ds_read_b128 v[24:27], v6 offset:46080
    v_mfma_f32_32x32x16_bf16 v[180:195], v[40:43], v[96:99], v[180:195]
    ds_read_b128 v[28:31], v7 offset:14336
    s_add_u32 s51, s59, 16
    s_and_b32 s51, s51, 31
    s_lshl_b32 s51, s51, 10
    s_add_u32 s51, s51, s55
    buffer_load_dwordx4 v[56:59], v2, s[8:11], s51 offen offset:0 sc1
    s_waitcnt vmcnt(8) lgkmcnt(3)
    v_mfma_f32_32x32x16_bf16 v[148:163], v[44:47], v[100:103], v[148:163]
    ds_read_b128 v[32:35], v6 offset:13312
    v_mfma_f32_32x32x16_bf16 v[164:179], v[48:51], v[100:103], v[164:179]
    ds_read_b128 v[36:39], v6 offset:47104
    v_mfma_f32_32x32x16_bf16 v[180:195], v[52:55], v[100:103], v[180:195]
    ds_read_b128 v[40:43], v7 offset:15360
    s_add_u32 s51, s59, 16
    s_and_b32 s51, s51, 31
    s_lshl_b32 s51, s51, 10
    s_add_u32 s51, s51, s55
    buffer_load_dwordx4 v[60:63], v2, s[8:11], s51 offen offset:1024 sc1
    s_waitcnt vmcnt(7) lgkmcnt(3)
    v_mfma_f32_32x32x16_bf16 v[148:163], v[20:23], v[104:107], v[148:163]
    ds_read_b128 v[44:47], v6 offset:14336
    v_mfma_f32_32x32x16_bf16 v[164:179], v[24:27], v[104:107], v[164:179]
    ds_read_b128 v[48:51], v6 offset:48128
    v_mfma_f32_32x32x16_bf16 v[180:195], v[28:31], v[104:107], v[180:195]
    ds_read_b128 v[52:55], v7 offset:16384
    s_add_u32 s51, s59, 16
    s_and_b32 s51, s51, 31
    s_lshl_b32 s51, s51, 10
    s_add_u32 s51, s51, s55
    buffer_load_dwordx4 v[64:67], v2, s[8:11], s51 offen offset:2048 sc1
    s_waitcnt vmcnt(3)
    s_barrier
    s_waitcnt vmcnt(7) lgkmcnt(3)
    v_mfma_f32_32x32x16_bf16 v[148:163], v[32:35], v[108:111], v[148:163]
    ds_read_b128 v[20:23], v6 offset:15360
    v_mfma_f32_32x32x16_bf16 v[164:179], v[36:39], v[108:111], v[164:179]
    ds_read_b128 v[24:27], v6 offset:49152
    v_mfma_f32_32x32x16_bf16 v[180:195], v[40:43], v[108:111], v[180:195]
    ds_read_b128 v[28:31], v7 offset:17408
    s_add_u32 s51, s59, 16
    s_and_b32 s51, s51, 31
    s_lshl_b32 s51, s51, 10
    s_add_u32 s51, s51, s55
    buffer_load_dwordx4 v[68:71], v2, s[8:11], s51 offen offset:3072 sc1
    s_waitcnt vmcnt(6) lgkmcnt(3)
    v_mfma_f32_32x32x16_bf16 v[148:163], v[44:47], v[112:115], v[148:163]
    ds_read_b128 v[32:35], v6 offset:16384
    v_mfma_f32_32x32x16_bf16 v[164:179], v[48:51], v[112:115], v[164:179]
    ds_read_b128 v[36:39], v6 offset:50176
    v_mfma_f32_32x32x16_bf16 v[180:195], v[52:55], v[112:115], v[180:195]
    ds_read_b128 v[40:43], v7 offset:18432
    s_add_u32 s51, s59, 20
    s_and_b32 s51, s51, 31
    s_lshl_b32 s51, s51, 10
    s_add_u32 s51, s51, s55
    buffer_load_dwordx4 v[72:75], v2, s[8:11], s51 offen offset:0 sc1
    s_lshl_b32 s50, s54, 12
    s_add_u32 s50, s50, 22282240
    buffer_load_dwordx4 v[120:123], v2, s[8:11], s50 offen offset:0 sc1
    buffer_load_dwordx4 v[124:127], v2, s[8:11], s50 offen offset:1024 sc1
    buffer_load_dwordx4 v[128:131], v2, s[8:11], s50 offen offset:2048 sc1
    buffer_load_dwordx4 v[132:135], v2, s[8:11], s50 offen offset:3072 sc1
    s_waitcnt vmcnt(10) lgkmcnt(3)
    v_mfma_f32_32x32x16_bf16 v[148:163], v[20:23], v[116:119], v[148:163]
    ds_read_b128 v[44:47], v6 offset:17408
    v_mfma_f32_32x32x16_bf16 v[164:179], v[24:27], v[116:119], v[164:179]
    ds_read_b128 v[48:51], v6 offset:51200
    v_mfma_f32_32x32x16_bf16 v[180:195], v[28:31], v[116:119], v[180:195]
    ds_read_b128 v[52:55], v7 offset:19456
    s_add_u32 s51, s59, 20
    s_and_b32 s51, s51, 31
    s_lshl_b32 s51, s51, 10
    s_add_u32 s51, s51, s55
    buffer_load_dwordx4 v[76:79], v2, s[8:11], s51 offen offset:1024 sc1
    s_waitcnt vmcnt(9) lgkmcnt(3)
    v_mfma_f32_32x32x16_bf16 v[148:163], v[32:35], v[56:59], v[148:163]
    ds_read_b128 v[20:23], v6 offset:18432
    v_mfma_f32_32x32x16_bf16 v[164:179], v[36:39], v[56:59], v[164:179]
    ds_read_b128 v[24:27], v6 offset:52224
    v_mfma_f32_32x32x16_bf16 v[180:195], v[40:43], v[56:59], v[180:195]
    ds_read_b128 v[28:31], v7 offset:20480
    s_add_u32 s51, s59, 20
    s_and_b32 s51, s51, 31
    s_lshl_b32 s51, s51, 10
    s_add_u32 s51, s51, s55
    buffer_load_dwordx4 v[80:83], v2, s[8:11], s51 offen offset:2048 sc1
    s_waitcnt vmcnt(9) lgkmcnt(3)
    v_mfma_f32_32x32x16_bf16 v[148:163], v[44:47], v[60:63], v[148:163]
    ds_read_b128 v[32:35], v6 offset:19456
    v_mfma_f32_32x32x16_bf16 v[164:179], v[48:51], v[60:63], v[164:179]
    ds_read_b128 v[36:39], v6 offset:53248
    v_mfma_f32_32x32x16_bf16 v[180:195], v[52:55], v[60:63], v[180:195]
    ds_read_b128 v[40:43], v7 offset:21504
    s_add_u32 s51, s59, 20
    s_and_b32 s51, s51, 31
    s_lshl_b32 s51, s51, 10
    s_add_u32 s51, s51, s55
    buffer_load_dwordx4 v[84:87], v2, s[8:11], s51 offen offset:3072 sc1
    s_waitcnt vmcnt(9) lgkmcnt(3)
    v_mfma_f32_32x32x16_bf16 v[148:163], v[20:23], v[64:67], v[148:163]
    ds_read_b128 v[44:47], v6 offset:20480
    v_mfma_f32_32x32x16_bf16 v[164:179], v[24:27], v[64:67], v[164:179]
    ds_read_b128 v[48:51], v6 offset:54272
    v_mfma_f32_32x32x16_bf16 v[180:195], v[28:31], v[64:67], v[180:195]
    ds_read_b128 v[52:55], v7 offset:22528
    s_add_u32 s51, s59, 24
    s_and_b32 s51, s51, 31
    s_lshl_b32 s51, s51, 10
    s_add_u32 s51, s51, s55
    buffer_load_dwordx4 v[88:91], v2, s[8:11], s51 offen offset:0 sc1
    s_waitcnt vmcnt(9) lgkmcnt(3)
    v_mfma_f32_32x32x16_bf16 v[148:163], v[32:35], v[68:71], v[148:163]
    ds_read_b128 v[20:23], v6 offset:21504
    v_mfma_f32_32x32x16_bf16 v[164:179], v[36:39], v[68:71], v[164:179]
    ds_read_b128 v[24:27], v6 offset:55296
    v_mfma_f32_32x32x16_bf16 v[180:195], v[40:43], v[68:71], v[180:195]
    ds_read_b128 v[28:31], v7 offset:23552
    s_add_u32 s51, s59, 24
    s_and_b32 s51, s51, 31
    s_lshl_b32 s51, s51, 10
    s_add_u32 s51, s51, s55
    buffer_load_dwordx4 v[92:95], v2, s[8:11], s51 offen offset:1024 sc1
    s_waitcnt vmcnt(9) lgkmcnt(3)
    v_mfma_f32_32x32x16_bf16 v[148:163], v[44:47], v[72:75], v[148:163]
    ds_read_b128 v[32:35], v6 offset:22528
    v_mfma_f32_32x32x16_bf16 v[164:179], v[48:51], v[72:75], v[164:179]
    ds_read_b128 v[36:39], v6 offset:56320
    v_mfma_f32_32x32x16_bf16 v[180:195], v[52:55], v[72:75], v[180:195]
    ds_read_b128 v[40:43], v7 offset:24576
    s_add_u32 s51, s59, 24
    s_and_b32 s51, s51, 31
    s_lshl_b32 s51, s51, 10
    s_add_u32 s51, s51, s55
    buffer_load_dwordx4 v[96:99], v2, s[8:11], s51 offen offset:2048 sc1
    s_waitcnt vmcnt(5) lgkmcnt(3)
    v_mfma_f32_32x32x16_bf16 v[148:163], v[20:23], v[76:79], v[148:163]
    ds_read_b128 v[44:47], v6 offset:23552
    v_mfma_f32_32x32x16_bf16 v[164:179], v[24:27], v[76:79], v[164:179]
    ds_read_b128 v[48:51], v6 offset:57344
    v_mfma_f32_32x32x16_bf16 v[180:195], v[28:31], v[76:79], v[180:195]
    ds_read_b128 v[52:55], v7 offset:25600
    s_add_u32 s51, s59, 24
    s_and_b32 s51, s51, 31
    s_lshl_b32 s51, s51, 10
    s_add_u32 s51, s51, s55
    buffer_load_dwordx4 v[100:103], v2, s[8:11], s51 offen offset:3072 sc1
    s_waitcnt vmcnt(5) lgkmcnt(3)
    v_mfma_f32_32x32x16_bf16 v[148:163], v[32:35], v[80:83], v[148:163]
    ds_read_b128 v[20:23], v6 offset:24576
    v_mfma_f32_32x32x16_bf16 v[164:179], v[36:39], v[80:83], v[164:179]
    ds_read_b128 v[24:27], v6 offset:58368
    v_mfma_f32_32x32x16_bf16 v[180:195], v[40:43], v[80:83], v[180:195]
    ds_read_b128 v[28:31], v7 offset:26624
    s_add_u32 s51, s59, 28
    s_and_b32 s51, s51, 31
    s_lshl_b32 s51, s51, 10
    s_add_u32 s51, s51, s55
    buffer_load_dwordx4 v[104:107], v2, s[8:11], s51 offen offset:0 sc1
    s_waitcnt vmcnt(5) lgkmcnt(3)
    v_mfma_f32_32x32x16_bf16 v[148:163], v[44:47], v[84:87], v[148:163]
    ds_read_b128 v[32:35], v6 offset:25600
    v_mfma_f32_32x32x16_bf16 v[164:179], v[48:51], v[84:87], v[164:179]
    ds_read_b128 v[36:39], v6 offset:59392
    v_mfma_f32_32x32x16_bf16 v[180:195], v[52:55], v[84:87], v[180:195]
    ds_read_b128 v[40:43], v7 offset:27648
    s_add_u32 s51, s59, 28
    s_and_b32 s51, s51, 31
    s_lshl_b32 s51, s51, 10
    s_add_u32 s51, s51, s55
    buffer_load_dwordx4 v[108:111], v2, s[8:11], s51 offen offset:1024 sc1
    s_waitcnt vmcnt(9)
    v_add_f32 v120, v120, v128
    v_add_f32 v121, v121, v129
    v_add_f32 v122, v122, v130
    v_add_f32 v123, v123, v131
    v_add_f32 v124, v124, v132
    v_add_f32 v125, v125, v133
    v_add_f32 v126, v126, v134
    v_add_f32 v127, v127, v135
    v_add_f32 v120, v120, v124
    v_add_f32 v121, v121, v125
    v_add_f32 v122, v122, v126
    v_add_f32 v123, v123, v127
    v_add_f32 v120, v120, v121
    v_add_f32 v122, v122, v123
    v_add_f32 v128, v120, v122
    v_add_f32 v129, v120, v122
    s_nop 1
    v_permlane32_swap_b32 v128, v129
    s_waitcnt vmcnt(5) lgkmcnt(3)
    v_mfma_f32_32x32x16_bf16 v[148:163], v[20:23], v[88:91], v[148:163]
    ds_read_b128 v[44:47], v6 offset:26624
    v_mfma_f32_32x32x16_bf16 v[164:179], v[24:27], v[88:91], v[164:179]
    ds_read_b128 v[48:51], v6 offset:60416
    v_mfma_f32_32x32x16_bf16 v[180:195], v[28:31], v[88:91], v[180:195]
    ds_read_b128 v[52:55], v7 offset:28672
    s_add_u32 s51, s59, 28
    s_and_b32 s51, s51, 31
    s_lshl_b32 s51, s51, 10
    s_add_u32 s51, s51, s55
    buffer_load_dwordx4 v[112:115], v2, s[8:11], s51 offen offset:2048 sc1
    s_waitcnt vmcnt(5) lgkmcnt(3)
    v_mfma_f32_32x32x16_bf16 v[148:163], v[32:35], v[92:95], v[148:163]
    ds_read_b128 v[20:23], v6 offset:27648
    v_mfma_f32_32x32x16_bf16 v[164:179], v[36:39], v[92:95], v[164:179]
    ds_read_b128 v[24:27], v6 offset:61440
    v_mfma_f32_32x32x16_bf16 v[180:195], v[40:43], v[92:95], v[180:195]
    ds_read_b128 v[28:31], v7 offset:29696
    s_add_u32 s51, s59, 28
    s_and_b32 s51, s51, 31
    s_lshl_b32 s51, s51, 10
    s_add_u32 s51, s51, s55
    buffer_load_dwordx4 v[116:119], v2, s[8:11], s51 offen offset:3072 sc1
    s_waitcnt vmcnt(5) lgkmcnt(3)
    v_mfma_f32_32x32x16_bf16 v[148:163], v[44:47], v[96:99], v[148:163]
    ds_read_b128 v[32:35], v6 offset:28672
    v_mfma_f32_32x32x16_bf16 v[164:179], v[48:51], v[96:99], v[164:179]
    ds_read_b128 v[36:39], v6 offset:62464
    v_mfma_f32_32x32x16_bf16 v[180:195], v[52:55], v[96:99], v[180:195]
    ds_read_b128 v[40:43], v7 offset:30720
    v_mul_f32 v120, 0x3b000000, v128
    v_mul_f32 v196, 0x3b000000, v129
    v_fma_f32 v196, -v120, v120, v196
    v_max_f32 v196, 0, v196
    v_add_f32 v196, 0x3727c5ac, v196
    v_rsq_f32 v3, v196
    v_sub_f32 v124, 0, v120
    v_cmp_gt_u32 vcc, 32, v1
    v_cvt_pk_bf16_f32 v125, v124, v124
    v_and_b32 v126, 0xffff0000, v125
    v_sub_f32 v126, v124, v126
    v_mov_b32 v127, 0
    v_cvt_pk_bf16_f32 v126, v126, v127
    v_mov_b32 v202, 0
    v_mov_b32 v203, 0
    v_cndmask_b32 v200, v127, v125, vcc
    v_cndmask_b32 v201, v127, v126, vcc
    v_mul_f32 v3, 0xbfb8aa3b, v3
    s_waitcnt vmcnt(4) lgkmcnt(3)
    v_mfma_f32_32x32x16_bf16 v[148:163], v[20:23], v[100:103], v[148:163]
    ds_read_b128 v[44:47], v6 offset:29696
    v_mfma_f32_32x32x16_bf16 v[164:179], v[24:27], v[100:103], v[164:179]
    ds_read_b128 v[48:51], v6 offset:63488
    v_mfma_f32_32x32x16_bf16 v[180:195], v[28:31], v[100:103], v[180:195]
    ds_read_b128 v[52:55], v7 offset:31744
    s_waitcnt vmcnt(3) lgkmcnt(3)
    v_mfma_f32_32x32x16_bf16 v[148:163], v[32:35], v[104:107], v[148:163]
    ds_read_b128 v[20:23], v6 offset:30720
    v_mfma_f32_32x32x16_bf16 v[164:179], v[36:39], v[104:107], v[164:179]
    ds_read_b128 v[24:27], v6 offset:64512
    v_mfma_f32_32x32x16_bf16 v[180:195], v[40:43], v[104:107], v[180:195]
    ds_read_b128 v[28:31], v7 offset:32768
    s_waitcnt vmcnt(2) lgkmcnt(3)
    v_mfma_f32_32x32x16_bf16 v[148:163], v[44:47], v[108:111], v[148:163]
    ds_read_b128 v[32:35], v6 offset:31744
    v_mfma_f32_32x32x16_bf16 v[164:179], v[48:51], v[108:111], v[164:179]
    ds_read_b128 v[36:39], v7 offset:0
    v_mfma_f32_32x32x16_bf16 v[180:195], v[52:55], v[108:111], v[180:195]
    ds_read_b128 v[40:43], v7 offset:33792
    s_waitcnt vmcnt(1) lgkmcnt(3)
    v_mfma_f32_32x32x16_bf16 v[148:163], v[20:23], v[112:115], v[148:163]
    ds_read_b128 v[44:47], v6 offset:32768
    v_mfma_f32_32x32x16_bf16 v[164:179], v[24:27], v[112:115], v[164:179]
    ds_read_b128 v[48:51], v7 offset:1024
    v_mfma_f32_32x32x16_bf16 v[180:195], v[28:31], v[112:115], v[180:195]
    ds_read_b128 v[52:55], v7 offset:34816
    s_waitcnt vmcnt(0) lgkmcnt(3)
    v_mfma_f32_32x32x16_bf16 v[148:163], v[32:35], v[116:119], v[148:163]
    v_mfma_f32_32x32x16_bf16 v[164:179], v[36:39], v[116:119], v[164:179]
    v_mfma_f32_32x32x16_bf16 v[180:195], v[40:43], v[116:119], v[180:195]
    s_waitcnt lgkmcnt(0)
    v_mfma_f32_32x32x16_bf16 v[148:163], v[44:47], v[200:203], v[148:163]
    v_mfma_f32_32x32x16_bf16 v[164:179], v[48:51], v[200:203], v[164:179]
    v_mfma_f32_32x32x16_bf16 v[180:195], v[52:55], v[200:203], v[180:195]
    s_mul_i32 s50, s54, 90112
    s_lshl_b32 s51, s53, 10
    s_add_u32 s50, s50, s51
    s_add_u32 s50, s50, 10485760
    s_nop 5
    v_mul_f32 v56, v148, v3
    v_mul_f32 v57, v149, v3
    v_mul_f32 v58, v150, v3
    v_mul_f32 v59, v151, v3
    v_mul_f32 v60, v152, v3
    v_mul_f32 v61, v153, v3
    v_mul_f32 v62, v154, v3
    v_mul_f32 v63, v155, v3
    v_exp_f32 v56, v56
    v_exp_f32 v57, v57
    v_exp_f32 v58, v58
    v_exp_f32 v59, v59
    v_exp_f32 v60, v60
    v_exp_f32 v61, v61
    v_exp_f32 v62, v62
    v_exp_f32 v63, v63
    v_mul_f32 v148, v148, v156
    v_mul_f32 v149, v149, v157
    v_mul_f32 v150, v150, v158
    v_mul_f32 v151, v151, v159
    v_mul_f32 v152, v152, v160
    v_mul_f32 v153, v153, v161
    v_mul_f32 v154, v154, v162
    v_mul_f32 v155, v155, v163
    v_fma_f32 v56, v56, v196, v196
    v_fma_f32 v57, v57, v196, v196
    v_fma_f32 v58, v58, v196, v196
    v_fma_f32 v59, v59, v196, v196
    v_fma_f32 v60, v60, v196, v196
    v_fma_f32 v61, v61, v196, v196
    v_fma_f32 v62, v62, v196, v196
    v_fma_f32 v63, v63, v196, v196
    v_rcp_f32 v56, v56
    v_rcp_f32 v57, v57
    v_rcp_f32 v58, v58
    v_rcp_f32 v59, v59
    v_rcp_f32 v60, v60
    v_rcp_f32 v61, v61
    v_rcp_f32 v62, v62
    v_rcp_f32 v63, v63
    s_nop 0
    v_mul_f32 v148, v148, v56
    v_mul_f32 v149, v149, v57
    v_mul_f32 v150, v150, v58
    v_mul_f32 v151, v151, v59
    v_mul_f32 v152, v152, v60
    v_mul_f32 v153, v153, v61
    v_mul_f32 v154, v154, v62
    v_mul_f32 v155, v155, v63
    v_cvt_pk_bf16_f32 v64, v148, v149
    v_cvt_pk_bf16_f32 v65, v150, v151
    v_cvt_pk_bf16_f32 v66, v152, v153
    v_cvt_pk_bf16_f32 v67, v154, v155
    buffer_store_dwordx4 v[64:67], v2, s[8:11], s50 offen offset:0 sc1
    v_mul_f32 v68, v164, v3
    v_mul_f32 v69, v165, v3
    v_mul_f32 v70, v166, v3
    v_mul_f32 v71, v167, v3
    v_mul_f32 v72, v168, v3
    v_mul_f32 v73, v169, v3
    v_mul_f32 v74, v170, v3
    v_mul_f32 v75, v171, v3
    v_exp_f32 v68, v68
    v_exp_f32 v69, v69
    v_exp_f32 v70, v70
    v_exp_f32 v71, v71
    v_exp_f32 v72, v72
    v_exp_f32 v73, v73
    v_exp_f32 v74, v74
    v_exp_f32 v75, v75
    v_mul_f32 v164, v164, v172
    v_mul_f32 v165, v165, v173
    v_mul_f32 v166, v166, v174
    v_mul_f32 v167, v167, v175
    v_mul_f32 v168, v168, v176
    v_mul_f32 v169, v169, v177
    v_mul_f32 v170, v170, v178
    v_mul_f32 v171, v171, v179
    v_fma_f32 v68, v68, v196, v196
    v_fma_f32 v69, v69, v196, v196
    v_fma_f32 v70, v70, v196, v196
    v_fma_f32 v71, v71, v196, v196
    v_fma_f32 v72, v72, v196, v196
    v_fma_f32 v73, v73, v196, v196
    v_fma_f32 v74, v74, v196, v196
    v_fma_f32 v75, v75, v196, v196
    v_rcp_f32 v68, v68
    v_rcp_f32 v69, v69
    v_rcp_f32 v70, v70
    v_rcp_f32 v71, v71
    v_rcp_f32 v72, v72
    v_rcp_f32 v73, v73
    v_rcp_f32 v74, v74
    v_rcp_f32 v75, v75
    s_nop 0
    v_mul_f32 v164, v164, v68
    v_mul_f32 v165, v165, v69
    v_mul_f32 v166, v166, v70
    v_mul_f32 v167, v167, v71
    v_mul_f32 v168, v168, v72
    v_mul_f32 v169, v169, v73
    v_mul_f32 v170, v170, v74
    v_mul_f32 v171, v171, v75
    v_cvt_pk_bf16_f32 v76, v164, v165
    v_cvt_pk_bf16_f32 v77, v166, v167
    v_cvt_pk_bf16_f32 v78, v168, v169
    v_cvt_pk_bf16_f32 v79, v170, v171
    buffer_store_dwordx4 v[76:79], v2, s[8:11], s50 offen offset:1024 sc1
    v_mul_f32 v80, v180, v3
    v_mul_f32 v81, v181, v3
    v_mul_f32 v82, v182, v3
    v_mul_f32 v83, v183, v3
    v_mul_f32 v84, v184, v3
    v_mul_f32 v85, v185, v3
    v_mul_f32 v86, v186, v3
    v_mul_f32 v87, v187, v3
    v_exp_f32 v80, v80
    v_exp_f32 v81, v81
    v_exp_f32 v82, v82
    v_exp_f32 v83, v83
    v_exp_f32 v84, v84
    v_exp_f32 v85, v85
    v_exp_f32 v86, v86
    v_exp_f32 v87, v87
    v_mul_f32 v180, v180, v188
    v_mul_f32 v181, v181, v189
    v_mul_f32 v182, v182, v190
    v_mul_f32 v183, v183, v191
    v_mul_f32 v184, v184, v192
    v_mul_f32 v185, v185, v193
    v_mul_f32 v186, v186, v194
    v_mul_f32 v187, v187, v195
    v_fma_f32 v80, v80, v196, v196
    v_fma_f32 v81, v81, v196, v196
    v_fma_f32 v82, v82, v196, v196
    v_fma_f32 v83, v83, v196, v196
    v_fma_f32 v84, v84, v196, v196
    v_fma_f32 v85, v85, v196, v196
    v_fma_f32 v86, v86, v196, v196
    v_fma_f32 v87, v87, v196, v196
    v_rcp_f32 v80, v80
    v_rcp_f32 v81, v81
    v_rcp_f32 v82, v82
    v_rcp_f32 v83, v83
    v_rcp_f32 v84, v84
    v_rcp_f32 v85, v85
    v_rcp_f32 v86, v86
    v_rcp_f32 v87, v87
    s_nop 0
    v_mul_f32 v180, v180, v80
    v_mul_f32 v181, v181, v81
    v_mul_f32 v182, v182, v82
    v_mul_f32 v183, v183, v83
    v_mul_f32 v184, v184, v84
    v_mul_f32 v185, v185, v85
    v_mul_f32 v186, v186, v86
    v_mul_f32 v187, v187, v87
    v_cvt_pk_bf16_f32 v88, v180, v181
    v_cvt_pk_bf16_f32 v89, v182, v183
    v_cvt_pk_bf16_f32 v90, v184, v185
    v_cvt_pk_bf16_f32 v91, v186, v187
    buffer_store_dwordx4 v[88:91], v2, s[8:11], s50 offen offset:2048 sc1
    s_branch L_sequential_preLN__softmax_full_mha__swiglu_ffn__prompt_p4_done_50
L_sequential_preLN__softmax_full_mha__swiglu_ffn__prompt_p4_idle_46:
    s_lshr_b32 s7, s2, 3
    s_cmp_lg_u32 s7, 29
    s_cbranch_scc1 L_sequential_preLN__softmax_full_mha__swiglu_ffn__prompt_noclean_51
    s_cmp_lg_u32 s3, 7
    s_cbranch_scc1 L_sequential_preLN__softmax_full_mha__swiglu_ffn__prompt_noclean_51
    v_and_b32 v17, 31, v1
    v_lshlrev_b32 v17, 2, v17
    s_add_u32 s44, s6, 22939648
    s_mov_b32 s45, 0
L_sequential_preLN__softmax_full_mha__swiglu_ffn__prompt_spin_52:
    s_add_u32 s45, s45, 1
    s_cmp_gt_u32 s45, 1048576
    s_cbranch_scc1 L_sequential_preLN__softmax_full_mha__swiglu_ffn__prompt_spin_out_53
    buffer_load_dword v16, v17, s[8:11], s44 offen sc1
    s_waitcnt vmcnt(0)
    v_cmp_ne_u32 vcc, 1, v16
    s_cbranch_vccnz L_sequential_preLN__softmax_full_mha__swiglu_ffn__prompt_spin_52
L_sequential_preLN__softmax_full_mha__swiglu_ffn__prompt_spin_out_53:
    buffer_wbl2 sc1
    s_waitcnt vmcnt(0)
L_sequential_preLN__softmax_full_mha__swiglu_ffn__prompt_noclean_51:
L_sequential_preLN__softmax_full_mha__swiglu_ffn__prompt_p4_done_50:
    s_lshr_b32 s7, s2, 3
    s_lshl_b32 s7, s7, 2
    s_add_u32 s7, s7, s6
    s_add_u32 s7, s7, 22940672
    v_mov_b32 v16, 1
    v_mov_b32 v17, 0
    s_cmp_ge_u32 s3, 4
    s_cbranch_scc1 L_sequential_preLN__softmax_full_mha__swiglu_ffn__prompt_p5_nopf_54
    s_and_b32 s50, s3, 1
    s_lshl_b32 s61, s50, 13
    s_lshl_b32 s51, s49, 1
    s_add_u32 s50, s50, s51
    s_mul_i32 s60, s50, 90112
    s_lshr_b32 s50, s3, 1
    s_lshl_b32 s50, s50, 12
    s_add_u32 s60, s60, s50
    s_add_u32 s60, s60, 17301504
    s_add_u32 s61, s61, s50
    s_add_u32 m0, s61, 114688
    s_add_u32 s50, s60, 0
    buffer_load_dwordx4 v2, s[8:11], s50 offen offset:0 sc1 lds
    buffer_load_dwordx4 v2, s[8:11], s50 offen offset:1024 sc1 lds
    buffer_load_dwordx4 v2, s[8:11], s50 offen offset:2048 sc1 lds
    buffer_load_dwordx4 v2, s[8:11], s50 offen offset:3072 sc1 lds
    s_add_u32 m0, s61, 131072
    s_add_u32 s50, s60, 8192
    buffer_load_dwordx4 v2, s[8:11], s50 offen offset:0 sc1 lds
    buffer_load_dwordx4 v2, s[8:11], s50 offen offset:1024 sc1 lds
    buffer_load_dwordx4 v2, s[8:11], s50 offen offset:2048 sc1 lds
    buffer_load_dwordx4 v2, s[8:11], s50 offen offset:3072 sc1 lds
    s_add_u32 m0, s61, 147456
    s_add_u32 s50, s60, 16384
    buffer_load_dwordx4 v2, s[8:11], s50 offen offset:0 sc1 lds
    buffer_load_dwordx4 v2, s[8:11], s50 offen offset:1024 sc1 lds
    buffer_load_dwordx4 v2, s[8:11], s50 offen offset:2048 sc1 lds
    buffer_load_dwordx4 v2, s[8:11], s50 offen offset:3072 sc1 lds
    s_waitcnt vmcnt(12)
    s_branch L_sequential_preLN__softmax_full_mha__swiglu_ffn__prompt_p5_pj_55
L_sequential_preLN__softmax_full_mha__swiglu_ffn__prompt_p5_nopf_54:
    s_waitcnt vmcnt(0)
L_sequential_preLN__softmax_full_mha__swiglu_ffn__prompt_p5_pj_55:
    s_barrier
    s_cmp_ge_u32 s52, 29
    s_cbranch_scc1 L_sequential_preLN__softmax_full_mha__swiglu_ffn__prompt_p4_noflag_56
    s_cmp_lg_u32 s3, 1
    s_cbranch_scc1 L_sequential_preLN__softmax_full_mha__swiglu_ffn__prompt_nopub_57
    s_mov_b64 exec, 1
    s_cmp_eq_u32 s46, 1
    s_cbranch_scc1 L_sequential_preLN__softmax_full_mha__swiglu_ffn__prompt_st_fast_58
    buffer_store_dword v16, v17, s[8:11], s7 offen sc1
    s_branch L_sequential_preLN__softmax_full_mha__swiglu_ffn__prompt_st_end_59
L_sequential_preLN__softmax_full_mha__swiglu_ffn__prompt_st_fast_58:
    buffer_store_dword v16, v17, s[8:11], s7 offen
L_sequential_preLN__softmax_full_mha__swiglu_ffn__prompt_st_end_59:
    s_mov_b64 exec, -1
L_sequential_preLN__softmax_full_mha__swiglu_ffn__prompt_nopub_57:
L_sequential_preLN__softmax_full_mha__swiglu_ffn__prompt_p4_noflag_56:
    s_cmp_ge_u32 s3, 4
    s_cbranch_scc1 L_sequential_preLN__softmax_full_mha__swiglu_ffn__prompt_p5_loader_60
    s_and_b32 s62, s3, 1
    s_lshr_b32 s63, s3, 1
    s_lshl_b32 s64, s48, 1
    s_add_u32 s64, s64, s63
    s_lshl_b32 s65, s49, 1
    s_add_u32 s65, s65, s62
    s_lshl_b32 s50, s62, 13
    v_add_u32 v197, s50, v2
    v_add_u32 v199, 65536, v197
    s_lshl_b32 s50, s63, 13
    v_add_u32 v198, s50, v2
    v_add_u32 v208, 65536, v198
    v_add_u32 v210, 65536, v199
    v_mov_b32 v148, 0
    v_mov_b32 v149, 0
    v_mov_b32 v150, 0
    v_mov_b32 v151, 0
    v_mov_b32 v152, 0
    v_mov_b32 v153, 0
    v_mov_b32 v154, 0
    v_mov_b32 v155, 0
    v_mov_b32 v156, 0
    v_mov_b32 v157, 0
    v_mov_b32 v158, 0
    v_mov_b32 v159, 0
    v_mov_b32 v160, 0
    v_mov_b32 v161, 0
    v_mov_b32 v162, 0
    v_mov_b32 v163, 0
    v_and_b32 v209, 31, v1
    v_lshlrev_b32 v209, 10, v209
    v_lshrrev_b32 v136, 5, v1
    v_lshl_add_u32 v209, v136, 4, v209
    s_cmp_lg_u32 s3, 0
    s_cbranch_scc1 L_sequential_preLN__softmax_full_mha__swiglu_ffn__prompt_nopoll_62
    v_and_b32 v17, 31, v1
    v_min_u32 v17, 28, v17
    v_lshlrev_b32 v17, 2, v17
    s_add_u32 s44, s6, 22940672
    s_mov_b32 s45, 0
L_sequential_preLN__softmax_full_mha__swiglu_ffn__prompt_spin_63:
    s_add_u32 s45, s45, 1
    s_cmp_gt_u32 s45, 1048576
    s_cbranch_scc1 L_sequential_preLN__softmax_full_mha__swiglu_ffn__prompt_spin_out_64
    buffer_load_dword v16, v17, s[8:11], s44 offen sc1
    s_waitcnt vmcnt(0)
    v_cmp_ne_u32 vcc, 1, v16
    s_cbranch_vccnz L_sequential_preLN__softmax_full_mha__swiglu_ffn__prompt_spin_63
L_sequential_preLN__softmax_full_mha__swiglu_ffn__prompt_spin_out_64:
L_sequential_preLN__softmax_full_mha__swiglu_ffn__prompt_nopoll_62:
    s_waitcnt vmcnt(0)
    s_barrier
    s_barrier
    ds_read_b128 v[56:59], v199 offset:49152
    ds_read_b128 v[80:83], v198 offset:32768
    ds_read_b128 v[60:63], v199 offset:50176
    ds_read_b128 v[84:87], v198 offset:33792
    ds_read_b128 v[64:67], v199 offset:51200
    ds_read_b128 v[88:91], v198 offset:34816
    ds_read_b128 v[68:71], v199 offset:52224
    ds_read_b128 v[92:95], v198 offset:35840
    ds_read_b128 v[72:75], v199 offset:53248
    ds_read_b128 v[96:99], v198 offset:36864
    ds_read_b128 v[76:79], v199 offset:54272
    ds_read_b128 v[100:103], v198 offset:37888
    s_waitcnt lgkmcnt(10)
    v_mfma_f32_32x32x16_bf16 v[148:163], v[56:59], v[80:83], v[148:163]
    ds_read_b128 v[56:59], v199 offset:55296
    ds_read_b128 v[80:83], v198 offset:38912
    s_waitcnt lgkmcnt(10)
    v_mfma_f32_32x32x16_bf16 v[148:163], v[60:63], v[84:87], v[148:163]
    ds_read_b128 v[60:63], v199 offset:56320
    ds_read_b128 v[84:87], v198 offset:39936
    s_waitcnt lgkmcnt(10)
    v_mfma_f32_32x32x16_bf16 v[148:163], v[64:67], v[88:91], v[148:163]
    s_waitcnt lgkmcnt(8)
    v_mfma_f32_32x32x16_bf16 v[148:163], v[68:71], v[92:95], v[148:163]
    s_waitcnt lgkmcnt(6)
    v_mfma_f32_32x32x16_bf16 v[148:163], v[72:75], v[96:99], v[148:163]
    s_waitcnt lgkmcnt(4)
    v_mfma_f32_32x32x16_bf16 v[148:163], v[76:79], v[100:103], v[148:163]
    s_waitcnt lgkmcnt(0)
    s_barrier
    ds_read_b128 v[64:67], v210 offset:0
    ds_read_b128 v[88:91], v198 offset:49152
    ds_read_b128 v[68:71], v210 offset:1024
    ds_read_b128 v[92:95], v198 offset:50176
    ds_read_b128 v[72:75], v210 offset:2048
    ds_read_b128 v[96:99], v198 offset:51200
    ds_read_b128 v[76:79], v210 offset:3072
    ds_read_b128 v[100:103], v198 offset:52224
    v_mfma_f32_32x32x16_bf16 v[148:163], v[56:59], v[80:83], v[148:163]
    ds_read_b128 v[56:59], v210 offset:4096
    ds_read_b128 v[80:83], v198 offset:53248
    s_waitcnt lgkmcnt(10)
    v_mfma_f32_32x32x16_bf16 v[148:163], v[60:63], v[84:87], v[148:163]
    ds_read_b128 v[60:63], v210 offset:5120
    ds_read_b128 v[84:87], v198 offset:54272
    s_waitcnt lgkmcnt(10)
    v_mfma_f32_32x32x16_bf16 v[148:163], v[64:67], v[88:91], v[148:163]
    ds_read_b128 v[64:67], v210 offset:6144
    ds_read_b128 v[88:91], v198 offset:55296
    s_waitcnt lgkmcnt(10)
    v_mfma_f32_32x32x16_bf16 v[148:163], v[68:71], v[92:95], v[148:163]
    ds_read_b128 v[68:71], v210 offset:7168
    ds_read_b128 v[92:95], v198 offset:56320
    s_waitcnt lgkmcnt(10)
    v_mfma_f32_32x32x16_bf16 v[148:163], v[72:75], v[96:99], v[148:163]
    s_waitcnt lgkmcnt(8)
    v_mfma_f32_32x32x16_bf16 v[148:163], v[76:79], v[100:103], v[148:163]
    s_waitcnt lgkmcnt(6)
    v_mfma_f32_32x32x16_bf16 v[148:163], v[56:59], v[80:83], v[148:163]
    s_waitcnt lgkmcnt(4)
    v_mfma_f32_32x32x16_bf16 v[148:163], v[60:63], v[84:87], v[148:163]
    s_waitcnt lgkmcnt(0)
    s_barrier
    ds_read_b128 v[72:75], v210 offset:16384
    ds_read_b128 v[96:99], v208 offset:0
    ds_read_b128 v[76:79], v210 offset:17408
    ds_read_b128 v[100:103], v208 offset:1024
    ds_read_b128 v[56:59], v210 offset:18432
    ds_read_b128 v[80:83], v208 offset:2048
    ds_read_b128 v[60:63], v210 offset:19456
    ds_read_b128 v[84:87], v208 offset:3072
    v_mfma_f32_32x32x16_bf16 v[148:163], v[64:67], v[88:91], v[148:163]
    ds_read_b128 v[64:67], v210 offset:20480
    ds_read_b128 v[88:91], v208 offset:4096
    s_waitcnt lgkmcnt(10)
    v_mfma_f32_32x32x16_bf16 v[148:163], v[68:71], v[92:95], v[148:163]
    ds_read_b128 v[68:71], v210 offset:21504
    ds_read_b128 v[92:95], v208 offset:5120
    s_waitcnt lgkmcnt(10)
    v_mfma_f32_32x32x16_bf16 v[148:163], v[72:75], v[96:99], v[148:163]
    ds_read_b128 v[72:75], v210 offset:22528
    ds_read_b128 v[96:99], v208 offset:6144
    s_waitcnt lgkmcnt(10)
    v_mfma_f32_32x32x16_bf16 v[148:163], v[76:79], v[100:103], v[148:163]
    ds_read_b128 v[76:79], v210 offset:23552
    ds_read_b128 v[100:103], v208 offset:7168
    s_waitcnt lgkmcnt(10)
    v_mfma_f32_32x32x16_bf16 v[148:163], v[56:59], v[80:83], v[148:163]
    s_waitcnt lgkmcnt(8)
    v_mfma_f32_32x32x16_bf16 v[148:163], v[60:63], v[84:87], v[148:163]
    s_waitcnt lgkmcnt(6)
    v_mfma_f32_32x32x16_bf16 v[148:163], v[64:67], v[88:91], v[148:163]
    s_waitcnt lgkmcnt(4)
    v_mfma_f32_32x32x16_bf16 v[148:163], v[68:71], v[92:95], v[148:163]
    s_waitcnt lgkmcnt(0)
    s_barrier
    ds_read_b128 v[56:59], v197 offset:0
    ds_read_b128 v[80:83], v208 offset:16384
    ds_read_b128 v[60:63], v197 offset:1024
    ds_read_b128 v[84:87], v208 offset:17408
    ds_read_b128 v[64:67], v197 offset:2048
    ds_read_b128 v[88:91], v208 offset:18432
    ds_read_b128 v[68:71], v197 offset:3072
    ds_read_b128 v[92:95], v208 offset:19456
    v_mfma_f32_32x32x16_bf16 v[148:163], v[72:75], v[96:99], v[148:163]
    ds_read_b128 v[72:75], v197 offset:4096
    ds_read_b128 v[96:99], v208 offset:20480
    s_waitcnt lgkmcnt(10)
    v_mfma_f32_32x32x16_bf16 v[148:163], v[76:79], v[100:103], v[148:163]
    ds_read_b128 v[76:79], v197 offset:5120
    ds_read_b128 v[100:103], v208 offset:21504
    s_waitcnt lgkmcnt(10)
    v_mfma_f32_32x32x16_bf16 v[148:163], v[56:59], v[80:83], v[148:163]
    ds_read_b128 v[56:59], v197 offset:6144
    ds_read_b128 v[80:83], v208 offset:22528
    s_waitcnt lgkmcnt(10)
    v_mfma_f32_32x32x16_bf16 v[148:163], v[60:63], v[84:87], v[148:163]
    ds_read_b128 v[60:63], v197 offset:7168
    ds_read_b128 v[84:87], v208 offset:23552
    s_waitcnt lgkmcnt(10)
    v_mfma_f32_32x32x16_bf16 v[148:163], v[64:67], v[88:91], v[148:163]
    s_waitcnt lgkmcnt(8)
    v_mfma_f32_32x32x16_bf16 v[148:163], v[68:71], v[92:95], v[148:163]
    s_waitcnt lgkmcnt(6)
    v_mfma_f32_32x32x16_bf16 v[148:163], v[72:75], v[96:99], v[148:163]
    s_waitcnt lgkmcnt(4)
    v_mfma_f32_32x32x16_bf16 v[148:163], v[76:79], v[100:103], v[148:163]
    s_waitcnt lgkmcnt(0)
    s_barrier
    ds_read_b128 v[64:67], v197 offset:16384
    ds_read_b128 v[88:91], v208 offset:32768
    ds_read_b128 v[68:71], v197 offset:17408
    ds_read_b128 v[92:95], v208 offset:33792
    ds_read_b128 v[72:75], v197 offset:18432
    ds_read_b128 v[96:99], v208 offset:34816
    ds_read_b128 v[76:79], v197 offset:19456
    ds_read_b128 v[100:103], v208 offset:35840
    v_mfma_f32_32x32x16_bf16 v[148:163], v[56:59], v[80:83], v[148:163]
    ds_read_b128 v[56:59], v197 offset:20480
    ds_read_b128 v[80:83], v208 offset:36864
    s_waitcnt lgkmcnt(10)
    v_mfma_f32_32x32x16_bf16 v[148:163], v[60:63], v[84:87], v[148:163]
    ds_read_b128 v[60:63], v197 offset:21504
    ds_read_b128 v[84:87], v208 offset:37888
    s_waitcnt lgkmcnt(10)
    v_mfma_f32_32x32x16_bf16 v[148:163], v[64:67], v[88:91], v[148:163]
    ds_read_b128 v[64:67], v197 offset:22528
    ds_read_b128 v[88:91], v208 offset:38912
    s_waitcnt lgkmcnt(10)
    v_mfma_f32_32x32x16_bf16 v[148:163], v[68:71], v[92:95], v[148:163]
    ds_read_b128 v[68:71], v197 offset:23552
    ds_read_b128 v[92:95], v208 offset:39936
    s_waitcnt lgkmcnt(10)
    v_mfma_f32_32x32x16_bf16 v[148:163], v[72:75], v[96:99], v[148:163]
    s_waitcnt lgkmcnt(8)
    v_mfma_f32_32x32x16_bf16 v[148:163], v[76:79], v[100:103], v[148:163]
    s_waitcnt lgkmcnt(6)
    v_mfma_f32_32x32x16_bf16 v[148:163], v[56:59], v[80:83], v[148:163]
    s_waitcnt lgkmcnt(4)
    v_mfma_f32_32x32x16_bf16 v[148:163], v[60:63], v[84:87], v[148:163]
    s_waitcnt lgkmcnt(0)
    s_barrier
    ds_read_b128 v[72:75], v199 offset:49152
    ds_read_b128 v[96:99], v198 offset:32768
    ds_read_b128 v[76:79], v199 offset:50176
    ds_read_b128 v[100:103], v198 offset:33792
    ds_read_b128 v[56:59], v199 offset:51200
    ds_read_b128 v[80:83], v198 offset:34816
    ds_read_b128 v[60:63], v199 offset:52224
    ds_read_b128 v[84:87], v198 offset:35840
    v_mfma_f32_32x32x16_bf16 v[148:163], v[64:67], v[88:91], v[148:163]
    ds_read_b128 v[64:67], v199 offset:53248
    ds_read_b128 v[88:91], v198 offset:36864
    s_waitcnt lgkmcnt(10)
    v_mfma_f32_32x32x16_bf16 v[148:163], v[68:71], v[92:95], v[148:163]
    ds_read_b128 v[68:71], v199 offset:54272
    ds_read_b128 v[92:95], v198 offset:37888
    s_waitcnt lgkmcnt(10)
    v_mfma_f32_32x32x16_bf16 v[148:163], v[72:75], v[96:99], v[148:163]
    ds_read_b128 v[72:75], v199 offset:55296
    ds_read_b128 v[96:99], v198 offset:38912
    s_waitcnt lgkmcnt(10)
    v_mfma_f32_32x32x16_bf16 v[148:163], v[76:79], v[100:103], v[148:163]
    ds_read_b128 v[76:79], v199 offset:56320
    ds_read_b128 v[100:103], v198 offset:39936
    s_waitcnt lgkmcnt(10)
    v_mfma_f32_32x32x16_bf16 v[148:163], v[56:59], v[80:83], v[148:163]
    s_waitcnt lgkmcnt(8)
    v_mfma_f32_32x32x16_bf16 v[148:163], v[60:63], v[84:87], v[148:163]
    s_waitcnt lgkmcnt(6)
    v_mfma_f32_32x32x16_bf16 v[148:163], v[64:67], v[88:91], v[148:163]
    s_waitcnt lgkmcnt(4)
    v_mfma_f32_32x32x16_bf16 v[148:163], v[68:71], v[92:95], v[148:163]
    s_waitcnt lgkmcnt(0)
    s_barrier
    ds_read_b128 v[56:59], v210 offset:0
    ds_read_b128 v[80:83], v198 offset:49152
    ds_read_b128 v[60:63], v210 offset:1024
    ds_read_b128 v[84:87], v198 offset:50176
    ds_read_b128 v[64:67], v210 offset:2048
    ds_read_b128 v[88:91], v198 offset:51200
    ds_read_b128 v[68:71], v210 offset:3072
    ds_read_b128 v[92:95], v198 offset:52224
    v_mfma_f32_32x32x16_bf16 v[148:163], v[72:75], v[96:99], v[148:163]
    ds_read_b128 v[72:75], v210 offset:4096
    ds_read_b128 v[96:99], v198 offset:53248
    s_waitcnt lgkmcnt(10)
    v_mfma_f32_32x32x16_bf16 v[148:163], v[76:79], v[100:103], v[148:163]
    ds_read_b128 v[76:79], v210 offset:5120
    ds_read_b128 v[100:103], v198 offset:54272
    s_waitcnt lgkmcnt(10)
    v_mfma_f32_32x32x16_bf16 v[148:163], v[56:59], v[80:83], v[148:163]
    ds_read_b128 v[56:59], v210 offset:6144
    ds_read_b128 v[80:83], v198 offset:55296
    s_waitcnt lgkmcnt(10)
    v_mfma_f32_32x32x16_bf16 v[148:163], v[60:63], v[84:87], v[148:163]
    ds_read_b128 v[60:63], v210 offset:7168
    ds_read_b128 v[84:87], v198 offset:56320
    s_waitcnt lgkmcnt(10)
    v_mfma_f32_32x32x16_bf16 v[148:163], v[64:67], v[88:91], v[148:163]
    s_waitcnt lgkmcnt(8)
    v_mfma_f32_32x32x16_bf16 v[148:163], v[68:71], v[92:95], v[148:163]
    s_waitcnt lgkmcnt(6)
    v_mfma_f32_32x32x16_bf16 v[148:163], v[72:75], v[96:99], v[148:163]
    s_waitcnt lgkmcnt(4)
    v_mfma_f32_32x32x16_bf16 v[148:163], v[76:79], v[100:103], v[148:163]
    s_waitcnt lgkmcnt(0)
    s_barrier
    ds_read_b128 v[64:67], v210 offset:16384
    ds_read_b128 v[88:91], v208 offset:0
    ds_read_b128 v[68:71], v210 offset:17408
    ds_read_b128 v[92:95], v208 offset:1024
    ds_read_b128 v[72:75], v210 offset:18432
    ds_read_b128 v[96:99], v208 offset:2048
    ds_read_b128 v[76:79], v210 offset:19456
    ds_read_b128 v[100:103], v208 offset:3072
    v_mfma_f32_32x32x16_bf16 v[148:163], v[56:59], v[80:83], v[148:163]
    ds_read_b128 v[56:59], v210 offset:20480
    ds_read_b128 v[80:83], v208 offset:4096
    s_waitcnt lgkmcnt(10)
    v_mfma_f32_32x32x16_bf16 v[148:163], v[60:63], v[84:87], v[148:163]
    ds_read_b128 v[60:63], v210 offset:21504
    ds_read_b128 v[84:87], v208 offset:5120
    s_waitcnt lgkmcnt(10)
    v_mfma_f32_32x32x16_bf16 v[148:163], v[64:67], v[88:91], v[148:163]
    ds_read_b128 v[64:67], v210 offset:22528
    ds_read_b128 v[88:91], v208 offset:6144
    s_waitcnt lgkmcnt(10)
    v_mfma_f32_32x32x16_bf16 v[148:163], v[68:71], v[92:95], v[148:163]
    ds_read_b128 v[68:71], v210 offset:23552
    ds_read_b128 v[92:95], v208 offset:7168
    s_waitcnt lgkmcnt(10)
    v_mfma_f32_32x32x16_bf16 v[148:163], v[72:75], v[96:99], v[148:163]
    s_waitcnt lgkmcnt(8)
    v_mfma_f32_32x32x16_bf16 v[148:163], v[76:79], v[100:103], v[148:163]
    s_waitcnt lgkmcnt(6)
    v_mfma_f32_32x32x16_bf16 v[148:163], v[56:59], v[80:83], v[148:163]
    s_waitcnt lgkmcnt(4)
    v_mfma_f32_32x32x16_bf16 v[148:163], v[60:63], v[84:87], v[148:163]
    s_waitcnt lgkmcnt(0)
    s_barrier
    ds_read_b128 v[72:75], v197 offset:0
    ds_read_b128 v[96:99], v208 offset:16384
    ds_read_b128 v[76:79], v197 offset:1024
    ds_read_b128 v[100:103], v208 offset:17408
    ds_read_b128 v[56:59], v197 offset:2048
    ds_read_b128 v[80:83], v208 offset:18432
    ds_read_b128 v[60:63], v197 offset:3072
    ds_read_b128 v[84:87], v208 offset:19456
    v_mfma_f32_32x32x16_bf16 v[148:163], v[64:67], v[88:91], v[148:163]
    ds_read_b128 v[64:67], v197 offset:4096
    ds_read_b128 v[88:91], v208 offset:20480
    s_waitcnt lgkmcnt(10)
    v_mfma_f32_32x32x16_bf16 v[148:163], v[68:71], v[92:95], v[148:163]
    ds_read_b128 v[68:71], v197 offset:5120
    ds_read_b128 v[92:95], v208 offset:21504
    s_waitcnt lgkmcnt(10)
    v_mfma_f32_32x32x16_bf16 v[148:163], v[72:75], v[96:99], v[148:163]
    ds_read_b128 v[72:75], v197 offset:6144
    ds_read_b128 v[96:99], v208 offset:22528
    s_waitcnt lgkmcnt(10)
    v_mfma_f32_32x32x16_bf16 v[148:163], v[76:79], v[100:103], v[148:163]
    ds_read_b128 v[76:79], v197 offset:7168
    ds_read_b128 v[100:103], v208 offset:23552
    s_waitcnt lgkmcnt(10)
    v_mfma_f32_32x32x16_bf16 v[148:163], v[56:59], v[80:83], v[148:163]
    s_waitcnt lgkmcnt(8)
    v_mfma_f32_32x32x16_bf16 v[148:163], v[60:63], v[84:87], v[148:163]
    s_waitcnt lgkmcnt(6)
    v_mfma_f32_32x32x16_bf16 v[148:163], v[64:67], v[88:91], v[148:163]
    s_waitcnt lgkmcnt(4)
    v_mfma_f32_32x32x16_bf16 v[148:163], v[68:71], v[92:95], v[148:163]
    s_waitcnt lgkmcnt(0)
    s_barrier
    ds_read_b128 v[56:59], v197 offset:16384
    ds_read_b128 v[80:83], v208 offset:32768
    ds_read_b128 v[60:63], v197 offset:17408
    ds_read_b128 v[84:87], v208 offset:33792
    ds_read_b128 v[64:67], v197 offset:18432
    ds_read_b128 v[88:91], v208 offset:34816
    ds_read_b128 v[68:71], v197 offset:19456
    ds_read_b128 v[92:95], v208 offset:35840
    v_mfma_f32_32x32x16_bf16 v[148:163], v[72:75], v[96:99], v[148:163]
    ds_read_b128 v[72:75], v197 offset:20480
    ds_read_b128 v[96:99], v208 offset:36864
    s_waitcnt lgkmcnt(10)
    v_mfma_f32_32x32x16_bf16 v[148:163], v[76:79], v[100:103], v[148:163]
    ds_read_b128 v[76:79], v197 offset:21504
    ds_read_b128 v[100:103], v208 offset:37888
    s_waitcnt lgkmcnt(10)
    v_mfma_f32_32x32x16_bf16 v[148:163], v[56:59], v[80:83], v[148:163]
    ds_read_b128 v[56:59], v197 offset:22528
    ds_read_b128 v[80:83], v208 offset:38912
    s_waitcnt lgkmcnt(10)
    v_mfma_f32_32x32x16_bf16 v[148:163], v[60:63], v[84:87], v[148:163]
    ds_read_b128 v[60:63], v197 offset:23552
    ds_read_b128 v[84:87], v208 offset:39936
    s_waitcnt lgkmcnt(10)
    v_mfma_f32_32x32x16_bf16 v[148:163], v[64:67], v[88:91], v[148:163]
    s_waitcnt lgkmcnt(8)
    v_mfma_f32_32x32x16_bf16 v[148:163], v[68:71], v[92:95], v[148:163]
    s_waitcnt lgkmcnt(6)
    v_mfma_f32_32x32x16_bf16 v[148:163], v[72:75], v[96:99], v[148:163]
    s_waitcnt lgkmcnt(4)
    v_mfma_f32_32x32x16_bf16 v[148:163], v[76:79], v[100:103], v[148:163]
    s_waitcnt lgkmcnt(0)
    s_barrier
    ds_read_b128 v[64:67], v199 offset:49152
    ds_read_b128 v[88:91], v198 offset:32768
    ds_read_b128 v[68:71], v199 offset:50176
    ds_read_b128 v[92:95], v198 offset:33792
    ds_read_b128 v[72:75], v199 offset:51200
    ds_read_b128 v[96:99], v198 offset:34816
    ds_read_b128 v[76:79], v199 offset:52224
    ds_read_b128 v[100:103], v198 offset:35840
    v_mfma_f32_32x32x16_bf16 v[148:163], v[56:59], v[80:83], v[148:163]
    ds_read_b128 v[56:59], v199 offset:53248
    ds_read_b128 v[80:83], v198 offset:36864
    s_waitcnt lgkmcnt(10)
    v_mfma_f32_32x32x16_bf16 v[148:163], v[60:63], v[84:87], v[148:163]
    ds_read_b128 v[60:63], v199 offset:54272
    ds_read_b128 v[84:87], v198 offset:37888
    s_waitcnt lgkmcnt(10)
    v_mfma_f32_32x32x16_bf16 v[148:163], v[64:67], v[88:91], v[148:163]
    s_waitcnt lgkmcnt(8)
    v_mfma_f32_32x32x16_bf16 v[148:163], v[68:71], v[92:95], v[148:163]
    s_waitcnt lgkmcnt(6)
    v_mfma_f32_32x32x16_bf16 v[148:163], v[72:75], v[96:99], v[148:163]
    s_waitcnt lgkmcnt(4)
    v_mfma_f32_32x32x16_bf16 v[148:163], v[76:79], v[100:103], v[148:163]
    s_waitcnt lgkmcnt(2)
    v_mfma_f32_32x32x16_bf16 v[148:163], v[56:59], v[80:83], v[148:163]
    s_waitcnt lgkmcnt(0)
    v_mfma_f32_32x32x16_bf16 v[148:163], v[60:63], v[84:87], v[148:163]
    s_lshl_b32 s50, s64, 15
    s_lshl_b32 s51, s65, 6
    s_add_u32 s50, s50, s51
    s_nop 8
    v_lshlrev_b32 v136, 16, v8
    v_and_b32 v137, 0xffff0000, v8
    v_add_f32 v148, v148, v136
    v_add_f32 v149, v149, v137
    v_lshlrev_b32 v138, 16, v9
    v_and_b32 v139, 0xffff0000, v9
    v_add_f32 v150, v150, v138
    v_add_f32 v151, v151, v139
    v_lshlrev_b32 v136, 16, v10
    v_and_b32 v137, 0xffff0000, v10
    v_add_f32 v152, v152, v136
    v_add_f32 v153, v153, v137
    v_lshlrev_b32 v138, 16, v11
    v_and_b32 v139, 0xffff0000, v11
    v_add_f32 v154, v154, v138
    v_add_f32 v155, v155, v139
    v_lshlrev_b32 v136, 16, v12
    v_and_b32 v137, 0xffff0000, v12
    v_add_f32 v156, v156, v136
    v_add_f32 v157, v157, v137
    v_lshlrev_b32 v138, 16, v13
    v_and_b32 v139, 0xffff0000, v13
    v_add_f32 v158, v158, v138
    v_add_f32 v159, v159, v139
    v_lshlrev_b32 v136, 16, v14
    v_and_b32 v137, 0xffff0000, v14
    v_add_f32 v160, v160, v136
    v_add_f32 v161, v161, v137
    v_lshlrev_b32 v138, 16, v15
    v_and_b32 v139, 0xffff0000, v15
    v_add_f32 v162, v162, v138
    v_add_f32 v163, v163, v139
    v_cvt_pk_bf16_f32 v140, v148, v149
    v_cvt_pk_bf16_f32 v141, v150, v151
    v_cvt_pk_bf16_f32 v142, v152, v153
    v_cvt_pk_bf16_f32 v143, v154, v155
    v_cvt_pk_bf16_f32 v144, v156, v157
    v_cvt_pk_bf16_f32 v145, v158, v159
    v_cvt_pk_bf16_f32 v146, v160, v161
    v_cvt_pk_bf16_f32 v147, v162, v163
    s_nop 1
    v_permlane32_swap_b32 v140, v142
    v_permlane32_swap_b32 v141, v143
    v_permlane32_swap_b32 v144, v146
    v_permlane32_swap_b32 v145, v147
    buffer_store_dwordx4 v[140:143], v209, s[36:39], s50 offen offset:0 nt
    buffer_store_dwordx4 v[144:147], v209, s[36:39], s50 offen offset:32 nt
    s_branch L_sequential_preLN__softmax_full_mha__swiglu_ffn__prompt_p5_done_61
L_sequential_preLN__softmax_full_mha__swiglu_ffn__prompt_p5_loader_60:
    s_and_b32 s63, s3, 1
    s_lshl_b32 s63, s63, 13
    s_cmp_ge_u32 s3, 6
    s_cbranch_scc1 L_sequential_preLN__softmax_full_mha__swiglu_ffn__prompt_p5_ldB_65
    s_lshl_b32 s50, s49, 1
    s_add_u32 s50, s50, s3
    s_sub_u32 s50, s50, 4
    s_mul_i32 s62, s50, 90112
    s_add_u32 s62, s62, 17301504
    s_add_u32 m0, s63, 0
    s_add_u32 s50, s62, 24576
    buffer_load_dwordx4 v2, s[8:11], s50 offen offset:0 sc1 lds
    buffer_load_dwordx4 v2, s[8:11], s50 offen offset:1024 sc1 lds
    buffer_load_dwordx4 v2, s[8:11], s50 offen offset:2048 sc1 lds
    buffer_load_dwordx4 v2, s[8:11], s50 offen offset:3072 sc1 lds
    s_add_u32 m0, s63, 4096
    s_add_u32 s50, s62, 28672
    buffer_load_dwordx4 v2, s[8:11], s50 offen offset:0 sc1 lds
    buffer_load_dwordx4 v2, s[8:11], s50 offen offset:1024 sc1 lds
    buffer_load_dwordx4 v2, s[8:11], s50 offen offset:2048 sc1 lds
    buffer_load_dwordx4 v2, s[8:11], s50 offen offset:3072 sc1 lds
    s_add_u32 m0, s63, 16384
    s_add_u32 s50, s62, 32768
    buffer_load_dwordx4 v2, s[8:11], s50 offen offset:0 sc1 lds
    buffer_load_dwordx4 v2, s[8:11], s50 offen offset:1024 sc1 lds
    buffer_load_dwordx4 v2, s[8:11], s50 offen offset:2048 sc1 lds
    buffer_load_dwordx4 v2, s[8:11], s50 offen offset:3072 sc1 lds
    s_add_u32 m0, s63, 20480
    s_add_u32 s50, s62, 36864
    buffer_load_dwordx4 v2, s[8:11], s50 offen offset:0 sc1 lds
    buffer_load_dwordx4 v2, s[8:11], s50 offen offset:1024 sc1 lds
    buffer_load_dwordx4 v2, s[8:11], s50 offen offset:2048 sc1 lds
    buffer_load_dwordx4 v2, s[8:11], s50 offen offset:3072 sc1 lds
    s_barrier
    s_barrier
    s_barrier
    s_add_u32 m0, s63, 114688
    s_add_u32 s50, s62, 40960
    buffer_load_dwordx4 v2, s[8:11], s50 offen offset:0 sc1 lds
    buffer_load_dwordx4 v2, s[8:11], s50 offen offset:1024 sc1 lds
    buffer_load_dwordx4 v2, s[8:11], s50 offen offset:2048 sc1 lds
    buffer_load_dwordx4 v2, s[8:11], s50 offen offset:3072 sc1 lds
    s_add_u32 m0, s63, 118784
    s_add_u32 s50, s62, 45056
    buffer_load_dwordx4 v2, s[8:11], s50 offen offset:0 sc1 lds
    buffer_load_dwordx4 v2, s[8:11], s50 offen offset:1024 sc1 lds
    buffer_load_dwordx4 v2, s[8:11], s50 offen offset:2048 sc1 lds
    buffer_load_dwordx4 v2, s[8:11], s50 offen offset:3072 sc1 lds
    s_barrier
    s_add_u32 m0, s63, 131072
    s_add_u32 s50, s62, 49152
    buffer_load_dwordx4 v2, s[8:11], s50 offen offset:0 sc1 lds
    buffer_load_dwordx4 v2, s[8:11], s50 offen offset:1024 sc1 lds
    buffer_load_dwordx4 v2, s[8:11], s50 offen offset:2048 sc1 lds
    buffer_load_dwordx4 v2, s[8:11], s50 offen offset:3072 sc1 lds
    s_add_u32 m0, s63, 135168
    s_add_u32 s50, s62, 53248
    buffer_load_dwordx4 v2, s[8:11], s50 offen offset:0 sc1 lds
    buffer_load_dwordx4 v2, s[8:11], s50 offen offset:1024 sc1 lds
    buffer_load_dwordx4 v2, s[8:11], s50 offen offset:2048 sc1 lds
    buffer_load_dwordx4 v2, s[8:11], s50 offen offset:3072 sc1 lds
    s_waitcnt vmcnt(24)
    s_barrier
    s_add_u32 m0, s63, 147456
    s_add_u32 s50, s62, 57344
    buffer_load_dwordx4 v2, s[8:11], s50 offen offset:0 sc1 lds
    buffer_load_dwordx4 v2, s[8:11], s50 offen offset:1024 sc1 lds
    buffer_load_dwordx4 v2, s[8:11], s50 offen offset:2048 sc1 lds
    buffer_load_dwordx4 v2, s[8:11], s50 offen offset:3072 sc1 lds
    s_add_u32 m0, s63, 151552
    s_add_u32 s50, s62, 61440
    buffer_load_dwordx4 v2, s[8:11], s50 offen offset:0 sc1 lds
    buffer_load_dwordx4 v2, s[8:11], s50 offen offset:1024 sc1 lds
    buffer_load_dwordx4 v2, s[8:11], s50 offen offset:2048 sc1 lds
    buffer_load_dwordx4 v2, s[8:11], s50 offen offset:3072 sc1 lds
    s_waitcnt vmcnt(24)
    s_barrier
    s_add_u32 m0, s63, 0
    s_add_u32 s50, s62, 65536
    buffer_load_dwordx4 v2, s[8:11], s50 offen offset:0 sc1 lds
    buffer_load_dwordx4 v2, s[8:11], s50 offen offset:1024 sc1 lds
    buffer_load_dwordx4 v2, s[8:11], s50 offen offset:2048 sc1 lds
    buffer_load_dwordx4 v2, s[8:11], s50 offen offset:3072 sc1 lds
    s_add_u32 m0, s63, 4096
    s_add_u32 s50, s62, 69632
    buffer_load_dwordx4 v2, s[8:11], s50 offen offset:0 sc1 lds
    buffer_load_dwordx4 v2, s[8:11], s50 offen offset:1024 sc1 lds
    buffer_load_dwordx4 v2, s[8:11], s50 offen offset:2048 sc1 lds
    buffer_load_dwordx4 v2, s[8:11], s50 offen offset:3072 sc1 lds
    s_waitcnt vmcnt(24)
    s_barrier
    s_add_u32 m0, s63, 16384
    s_add_u32 s50, s62, 73728
    buffer_load_dwordx4 v2, s[8:11], s50 offen offset:0 sc1 lds
    buffer_load_dwordx4 v2, s[8:11], s50 offen offset:1024 sc1 lds
    buffer_load_dwordx4 v2, s[8:11], s50 offen offset:2048 sc1 lds
    buffer_load_dwordx4 v2, s[8:11], s50 offen offset:3072 sc1 lds
    s_add_u32 m0, s63, 20480
    s_add_u32 s50, s62, 77824
    buffer_load_dwordx4 v2, s[8:11], s50 offen offset:0 sc1 lds
    buffer_load_dwordx4 v2, s[8:11], s50 offen offset:1024 sc1 lds
    buffer_load_dwordx4 v2, s[8:11], s50 offen offset:2048 sc1 lds
    buffer_load_dwordx4 v2, s[8:11], s50 offen offset:3072 sc1 lds
    s_waitcnt vmcnt(24)
    s_barrier
    s_add_u32 m0, s63, 114688
    s_add_u32 s50, s62, 81920
    buffer_load_dwordx4 v2, s[8:11], s50 offen offset:0 sc1 lds
    buffer_load_dwordx4 v2, s[8:11], s50 offen offset:1024 sc1 lds
    buffer_load_dwordx4 v2, s[8:11], s50 offen offset:2048 sc1 lds
    buffer_load_dwordx4 v2, s[8:11], s50 offen offset:3072 sc1 lds
    s_add_u32 m0, s63, 118784
    s_add_u32 s50, s62, 86016
    buffer_load_dwordx4 v2, s[8:11], s50 offen offset:0 sc1 lds
    buffer_load_dwordx4 v2, s[8:11], s50 offen offset:1024 sc1 lds
    s_waitcnt vmcnt(22)
    s_barrier
    s_waitcnt vmcnt(14)
    s_barrier
    s_waitcnt vmcnt(6)
    s_barrier
    s_waitcnt vmcnt(0)
    s_barrier
    s_branch L_sequential_preLN__softmax_full_mha__swiglu_ffn__prompt_p5_done_61
L_sequential_preLN__softmax_full_mha__swiglu_ffn__prompt_p5_ldB_65:
    s_lshl_b32 s50, s48, 1
    s_add_u32 s50, s50, s3
    s_sub_u32 s50, s50, 6
    s_mul_i32 s62, s50, 90112
    s_add_u32 s62, s62, 10485760
    s_barrier
    s_add_u32 m0, s63, 32768
    s_add_u32 s50, s62, 0
    buffer_load_dwordx4 v2, s[8:11], s50 offen offset:0 sc1 lds
    buffer_load_dwordx4 v2, s[8:11], s50 offen offset:1024 sc1 lds
    buffer_load_dwordx4 v2, s[8:11], s50 offen offset:2048 sc1 lds
    buffer_load_dwordx4 v2, s[8:11], s50 offen offset:3072 sc1 lds
    s_add_u32 m0, s63, 36864
    s_add_u32 s50, s62, 4096
    buffer_load_dwordx4 v2, s[8:11], s50 offen offset:0 sc1 lds
    buffer_load_dwordx4 v2, s[8:11], s50 offen offset:1024 sc1 lds
    buffer_load_dwordx4 v2, s[8:11], s50 offen offset:2048 sc1 lds
    buffer_load_dwordx4 v2, s[8:11], s50 offen offset:3072 sc1 lds
    s_add_u32 m0, s63, 49152
    s_add_u32 s50, s62, 8192
    buffer_load_dwordx4 v2, s[8:11], s50 offen offset:0 sc1 lds
    buffer_load_dwordx4 v2, s[8:11], s50 offen offset:1024 sc1 lds
    buffer_load_dwordx4 v2, s[8:11], s50 offen offset:2048 sc1 lds
    buffer_load_dwordx4 v2, s[8:11], s50 offen offset:3072 sc1 lds
    s_add_u32 m0, s63, 53248
    s_add_u32 s50, s62, 12288
    buffer_load_dwordx4 v2, s[8:11], s50 offen offset:0 sc1 lds
    buffer_load_dwordx4 v2, s[8:11], s50 offen offset:1024 sc1 lds
    buffer_load_dwordx4 v2, s[8:11], s50 offen offset:2048 sc1 lds
    buffer_load_dwordx4 v2, s[8:11], s50 offen offset:3072 sc1 lds
    s_waitcnt vmcnt(8)
    s_barrier
    s_add_u32 m0, s63, 65536
    s_add_u32 s50, s62, 16384
    buffer_load_dwordx4 v2, s[8:11], s50 offen offset:0 sc1 lds
    buffer_load_dwordx4 v2, s[8:11], s50 offen offset:1024 sc1 lds
    buffer_load_dwordx4 v2, s[8:11], s50 offen offset:2048 sc1 lds
    buffer_load_dwordx4 v2, s[8:11], s50 offen offset:3072 sc1 lds
    s_add_u32 m0, s63, 69632
    s_add_u32 s50, s62, 20480
    buffer_load_dwordx4 v2, s[8:11], s50 offen offset:0 sc1 lds
    buffer_load_dwordx4 v2, s[8:11], s50 offen offset:1024 sc1 lds
    buffer_load_dwordx4 v2, s[8:11], s50 offen offset:2048 sc1 lds
    buffer_load_dwordx4 v2, s[8:11], s50 offen offset:3072 sc1 lds
    s_add_u32 m0, s63, 81920
    s_add_u32 s50, s62, 24576
    buffer_load_dwordx4 v2, s[8:11], s50 offen offset:0 sc1 lds
    buffer_load_dwordx4 v2, s[8:11], s50 offen offset:1024 sc1 lds
    buffer_load_dwordx4 v2, s[8:11], s50 offen offset:2048 sc1 lds
    buffer_load_dwordx4 v2, s[8:11], s50 offen offset:3072 sc1 lds
    s_add_u32 m0, s63, 86016
    s_add_u32 s50, s62, 28672
    buffer_load_dwordx4 v2, s[8:11], s50 offen offset:0 sc1 lds
    buffer_load_dwordx4 v2, s[8:11], s50 offen offset:1024 sc1 lds
    buffer_load_dwordx4 v2, s[8:11], s50 offen offset:2048 sc1 lds
    buffer_load_dwordx4 v2, s[8:11], s50 offen offset:3072 sc1 lds
    s_waitcnt vmcnt(16)
    s_barrier
    s_add_u32 m0, s63, 98304
    s_add_u32 s50, s62, 32768
    buffer_load_dwordx4 v2, s[8:11], s50 offen offset:0 sc1 lds
    buffer_load_dwordx4 v2, s[8:11], s50 offen offset:1024 sc1 lds
    buffer_load_dwordx4 v2, s[8:11], s50 offen offset:2048 sc1 lds
    buffer_load_dwordx4 v2, s[8:11], s50 offen offset:3072 sc1 lds
    s_add_u32 m0, s63, 102400
    s_add_u32 s50, s62, 36864
    buffer_load_dwordx4 v2, s[8:11], s50 offen offset:0 sc1 lds
    buffer_load_dwordx4 v2, s[8:11], s50 offen offset:1024 sc1 lds
    buffer_load_dwordx4 v2, s[8:11], s50 offen offset:2048 sc1 lds
    buffer_load_dwordx4 v2, s[8:11], s50 offen offset:3072 sc1 lds
    s_waitcnt vmcnt(16)
    s_barrier
    s_add_u32 m0, s63, 32768
    s_add_u32 s50, s62, 40960
    buffer_load_dwordx4 v2, s[8:11], s50 offen offset:0 sc1 lds
    buffer_load_dwordx4 v2, s[8:11], s50 offen offset:1024 sc1 lds
    buffer_load_dwordx4 v2, s[8:11], s50 offen offset:2048 sc1 lds
    buffer_load_dwordx4 v2, s[8:11], s50 offen offset:3072 sc1 lds
    s_add_u32 m0, s63, 36864
    s_add_u32 s50, s62, 45056
    buffer_load_dwordx4 v2, s[8:11], s50 offen offset:0 sc1 lds
    buffer_load_dwordx4 v2, s[8:11], s50 offen offset:1024 sc1 lds
    buffer_load_dwordx4 v2, s[8:11], s50 offen offset:2048 sc1 lds
    buffer_load_dwordx4 v2, s[8:11], s50 offen offset:3072 sc1 lds
    s_waitcnt vmcnt(16)
    s_barrier
    s_add_u32 m0, s63, 49152
    s_add_u32 s50, s62, 49152
    buffer_load_dwordx4 v2, s[8:11], s50 offen offset:0 sc1 lds
    buffer_load_dwordx4 v2, s[8:11], s50 offen offset:1024 sc1 lds
    buffer_load_dwordx4 v2, s[8:11], s50 offen offset:2048 sc1 lds
    buffer_load_dwordx4 v2, s[8:11], s50 offen offset:3072 sc1 lds
    s_add_u32 m0, s63, 53248
    s_add_u32 s50, s62, 53248
    buffer_load_dwordx4 v2, s[8:11], s50 offen offset:0 sc1 lds
    buffer_load_dwordx4 v2, s[8:11], s50 offen offset:1024 sc1 lds
    buffer_load_dwordx4 v2, s[8:11], s50 offen offset:2048 sc1 lds
    buffer_load_dwordx4 v2, s[8:11], s50 offen offset:3072 sc1 lds
    s_waitcnt vmcnt(16)
    s_barrier
    s_add_u32 m0, s63, 65536
    s_add_u32 s50, s62, 57344
    buffer_load_dwordx4 v2, s[8:11], s50 offen offset:0 sc1 lds
    buffer_load_dwordx4 v2, s[8:11], s50 offen offset:1024 sc1 lds
    buffer_load_dwordx4 v2, s[8:11], s50 offen offset:2048 sc1 lds
    buffer_load_dwordx4 v2, s[8:11], s50 offen offset:3072 sc1 lds
    s_add_u32 m0, s63, 69632
    s_add_u32 s50, s62, 61440
    buffer_load_dwordx4 v2, s[8:11], s50 offen offset:0 sc1 lds
    buffer_load_dwordx4 v2, s[8:11], s50 offen offset:1024 sc1 lds
    buffer_load_dwordx4 v2, s[8:11], s50 offen offset:2048 sc1 lds
    buffer_load_dwordx4 v2, s[8:11], s50 offen offset:3072 sc1 lds
    s_waitcnt vmcnt(16)
    s_barrier
    s_add_u32 m0, s63, 81920
    s_add_u32 s50, s62, 65536
    buffer_load_dwordx4 v2, s[8:11], s50 offen offset:0 sc1 lds
    buffer_load_dwordx4 v2, s[8:11], s50 offen offset:1024 sc1 lds
    buffer_load_dwordx4 v2, s[8:11], s50 offen offset:2048 sc1 lds
    buffer_load_dwordx4 v2, s[8:11], s50 offen offset:3072 sc1 lds
    s_add_u32 m0, s63, 86016
    s_add_u32 s50, s62, 69632
    buffer_load_dwordx4 v2, s[8:11], s50 offen offset:0 sc1 lds
    buffer_load_dwordx4 v2, s[8:11], s50 offen offset:1024 sc1 lds
    buffer_load_dwordx4 v2, s[8:11], s50 offen offset:2048 sc1 lds
    buffer_load_dwordx4 v2, s[8:11], s50 offen offset:3072 sc1 lds
    s_waitcnt vmcnt(16)
    s_barrier
    s_add_u32 m0, s63, 98304
    s_add_u32 s50, s62, 73728
    buffer_load_dwordx4 v2, s[8:11], s50 offen offset:0 sc1 lds
    buffer_load_dwordx4 v2, s[8:11], s50 offen offset:1024 sc1 lds
    buffer_load_dwordx4 v2, s[8:11], s50 offen offset:2048 sc1 lds
    buffer_load_dwordx4 v2, s[8:11], s50 offen offset:3072 sc1 lds
    s_add_u32 m0, s63, 102400
    s_add_u32 s50, s62, 77824
    buffer_load_dwordx4 v2, s[8:11], s50 offen offset:0 sc1 lds
    buffer_load_dwordx4 v2, s[8:11], s50 offen offset:1024 sc1 lds
    buffer_load_dwordx4 v2, s[8:11], s50 offen offset:2048 sc1 lds
    buffer_load_dwordx4 v2, s[8:11], s50 offen offset:3072 sc1 lds
    s_waitcnt vmcnt(16)
    s_barrier
    s_add_u32 m0, s63, 32768
    s_add_u32 s50, s62, 81920
    buffer_load_dwordx4 v2, s[8:11], s50 offen offset:0 sc1 lds
    buffer_load_dwordx4 v2, s[8:11], s50 offen offset:1024 sc1 lds
    buffer_load_dwordx4 v2, s[8:11], s50 offen offset:2048 sc1 lds
    buffer_load_dwordx4 v2, s[8:11], s50 offen offset:3072 sc1 lds
    s_add_u32 m0, s63, 36864
    s_add_u32 s50, s62, 86016
    buffer_load_dwordx4 v2, s[8:11], s50 offen offset:0 sc1 lds
    buffer_load_dwordx4 v2, s[8:11], s50 offen offset:1024 sc1 lds
    s_waitcnt vmcnt(14)
    s_barrier
    s_waitcnt vmcnt(6)
    s_barrier
    s_waitcnt vmcnt(0)
    s_barrier
L_sequential_preLN__softmax_full_mha__swiglu_ffn__prompt_p5_done_61:
L_sequential_preLN__softmax_full_mha__swiglu_ffn__prompt_end_1:
    s_endpgm
.section .rodata,"a"
.p2align 6
.amdhsa_kernel sequential_preLN__softmax_full_mha__swiglu_ffn__prompt_kernel
  .amdhsa_next_free_vgpr 216
  .amdhsa_next_free_sgpr 68
  .amdhsa_accum_offset 216
  .amdhsa_group_segment_fixed_size 0
  .amdhsa_kernarg_size 80
  .amdhsa_user_sgpr_count 2
  .amdhsa_user_sgpr_kernarg_segment_ptr 1
  .amdhsa_system_sgpr_workgroup_id_x 1
.end_amdhsa_kernel
```
